```python
import torch

def _softmax(x, axis=-1):
    return torch.softmax(x, dim=axis)
def _gelu(x):
    return torch.nn.functional.gelu(x, approximate="tanh")
def _silu(x):
    return torch.nn.functional.silu(x)
def _sigmoid(x):
    return torch.sigmoid(x)
def _layernorm(x, axis=-1, eps=1e-5):
    m = x.mean(dim=axis, keepdim=True)
    v = x.var(dim=axis, keepdim=True, unbiased=False)
    return (x - m) / torch.sqrt(v + eps)
def _scatter_add(tgt, idx, src, axis=0):
    return tgt.clone().index_add_(axis, idx, src)
def _segment_sum(src, seg, n):
    out = torch.zeros((n,) + src.shape[1:], dtype=src.dtype)
    return out.index_add_(0, seg, src)
def _pad(x, pw):
    flat = tuple(v for pair in reversed(pw) for v in pair)
    return torch.nn.functional.pad(x, flat)

kernel_name = 'parallel_sum__gqa_block_cached__swiglu_ffn__decode'

def setup_inputs():

    _w = (lambda a: (lambda t: t.to(torch.bfloat16) if t.is_floating_point() else t)(torch.as_tensor(a)))
    def _A_setup():
        B, Sq, D = 1, 1, 1024
        Hq, Hkv, Sk, Dh = 32, 4, 65536, 128
        assert Hq % Hkv == 0, (Hq, Hkv)
        return {
            "x": _w((lambda *s: torch.randn(*s, dtype=torch.bfloat16) * 0.05)(B, Sq, D)),
            "k_cache": _w((lambda *s: torch.randn(*s, dtype=torch.bfloat16) * 3.2)(B, Hkv, Sk, Dh)),
            "v_cache": _w((lambda *s: torch.randn(*s, dtype=torch.bfloat16) * 1.6)(B, Hkv, Sk, Dh)),
            "wq": _w((lambda *s: torch.randn(*s, dtype=torch.bfloat16) * 3.2)(D, Hq * Dh) * (D ** -0.5)),
            "wo": _w((lambda *s: torch.randn(*s, dtype=torch.bfloat16) * 1.6)(Hq * Dh, D) * ((Hq * Dh) ** -0.5)),
        }
    _A_in = _A_setup()

    def _B_setup():
        B, S, D, F = 1, 1, 1024, 3584
        return {
            "x": _w((lambda *s: torch.randn(*s, dtype=torch.bfloat16) * 0.05)(B, S, D)),
            "w_gate": _w((lambda *s: torch.randn(*s, dtype=torch.bfloat16) * 0.05)(D, F)),
            "w_up": _w((lambda *s: torch.randn(*s, dtype=torch.bfloat16) * 0.05)(D, F)),
            "w_down": _w((lambda *s: torch.randn(*s, dtype=torch.bfloat16) * 0.05)(F, D)),
        }
    _B_in = _B_setup()

    return {
        "A_x": _A_in["x"],
        "A_k_cache": _A_in["k_cache"],
        "A_v_cache": _A_in["v_cache"],
        "A_wq": _A_in["wq"],
        "A_wo": _A_in["wo"],
        "B_x": _B_in["x"],
        "B_w_gate": _B_in["w_gate"],
        "B_w_up": _B_in["w_up"],
        "B_w_down": _B_in["w_down"],
    }

def reference(A_x, A_k_cache, A_v_cache, A_wq, A_wo, B_x, B_w_gate, B_w_up, B_w_down):
    def _A_ref(x, k_cache, v_cache, wq, wo):
        B, Sq, D = x.shape
        Hq, Dh = 32, 128
        Hkv = k_cache.shape[1]
        rep = Hq // Hkv
        q = (lambda x, *d: x.permute(*d))((x @ wq).reshape(B, Sq, Hq, Dh), 0, 2, 1, 3)
        k = (lambda x, n, axis: torch.repeat_interleave(x, n, dim=axis))(k_cache, rep, axis=1)
        v = (lambda x, n, axis: torch.repeat_interleave(x, n, dim=axis))(v_cache, rep, axis=1)
        scores = torch.einsum("bhqd,bhkd->bhqk", q, k) * (Dh ** -0.5)
        p = _softmax(scores, axis=-1)
        o = torch.einsum("bhqk,bhkd->bhqd", p, v)
        return (lambda x, *d: x.permute(*d))(o, 0, 2, 1, 3).reshape(B, Sq, Hq * Dh) @ wo

    def _B_ref(x, w_gate, w_up, w_down):
        g = _silu(x @ w_gate)
        u = x @ w_up
        return (g * u) @ w_down

    x = A_x
    xn = _layernorm(x, axis=-1)
    return x + _A_ref(xn, A_k_cache, A_v_cache, A_wq, A_wo) + _B_ref(xn, B_w_gate, B_w_up, B_w_down)
```

```asm
; @launch grid=(256,1,1) block=(512,1,1) lds=103424
.amdgcn_target "amdgcn-amd-amdhsa--gfx950"
.text
.globl parallel_sum__gqa_block_cached__swiglu_ffn__decode_kernel
.p2align 8
.type parallel_sum__gqa_block_cached__swiglu_ffn__decode_kernel,@function
parallel_sum__gqa_block_cached__swiglu_ffn__decode_kernel:
    s_cmp_ge_u32 s2, 256
    s_cbranch_scc1 L_end
    s_load_dwordx16 s[64:79], s[0:1], 0
    s_load_dwordx8 s[80:87], s[0:1], 64
    v_and_b32 v1, 63, v0
    v_lshrrev_b32 v2, 6, v0
    s_nop 0
    v_readfirstlane_b32 s3, v2
    s_mov_b32 s48, s2
    s_lshr_b32 s50, s48, 6
    s_and_b32 s51, s48, 63
    s_and_b32 s53, s48, 15
    s_lshr_b32 s52, s48, 4
    s_add_u32 s52, s52, s53
    s_and_b32 s52, s52, 15
    s_and_b32 s56, s52, 7
    s_cmp_lg_u32 s56, 7
    s_cselect_b32 s55, 7340032, 0
    s_lshr_b32 s56, s52, 3
    s_sub_u32 s52, s52, s56
    s_and_b32 s54, s3, 3
    s_mov_b32 s60, 0x05040100
    s_mov_b32 s61, 0x07060302
    s_mov_b32 s62, 0xffff0000
    s_mov_b32 s63, 0x3fb8aa3b
    s_mov_b32 s59, 0x3db504f3
    s_mov_b32 s90, 0x07060501
    s_mov_b32 s91, 0x07060100
    s_mov_b32 s94, 0x0706000c
    s_mov_b32 s95, 0xffffff00
    v_mov_b32 v14, 0
    v_lshlrev_b32 v13, 2, v1
    ds_write_b32 v13, v14
    v_lshlrev_b32 v8, 4, v1
    v_lshrrev_b32 v9, 4, v1
    v_and_b32 v10, 15, v1
    v_lshlrev_b32 v2, 5, v1
    v_lshrrev_b32 v3, 5, v1
    v_and_b32 v12, 31, v1
    v_lshlrev_b32 v12, 4, v12
    v_lshl_add_u32 v5, v3, 16, v12
    s_mov_b32 s56, 57344
    v_mad_u32_u24 v6, v3, s56, v12
    v_lshlrev_b32 v3, 4, v3
    v_and_b32 v4, 7, v1
    v_lshlrev_b32 v4, 4, v4
    v_bfe_u32 v7, v1, 1, 1
    v_lshlrev_b32 v7, 10, v7
    v_bfe_u32 v15, v1, 2, 2
    v_lshl_add_u32 v7, v15, 8, v7
    v_lshl_add_u32 v7, v9, 5, v7
    v_and_b32 v15, 1, v1
    v_lshl_add_u32 v7, v15, 4, v7
    v_mov_b32 v15, 1
    s_lshl_b32 s4, s50, 24
    s_lshl_b32 s5, s51, 15
    s_add_u32 s4, s4, s5
    s_mul_i32 s5, s54, 10240
    s_add_u32 s4, s4, s5
    s_lshl_b32 s97, s53, 6
    s_lshl_b32 s5, s54, 4
    s_add_u32 s97, s97, s5
    s_waitcnt lgkmcnt(0)
    s_mov_b32 s8, s64
    s_mov_b32 s9, s65
    s_mov_b32 s10, 2048
    s_mov_b32 s11, 0x20000
    s_mov_b32 s20, s70
    s_mov_b32 s21, s71
    s_mov_b32 s22, 8388608
    s_mov_b32 s23, 0x20000
    s_cmp_lt_u32 s3, 4
    s_cbranch_scc1 L_pro2
    s_setprio 3
    s_load_dword s49, s[86:87], 4
    buffer_load_dwordx4 v[32:35], v2, s[8:11], 0 offen
    buffer_load_dwordx4 v[36:39], v2, s[8:11], 0 offen offset:16
    s_lshl_b32 s5, s97, 1
    buffer_load_dwordx4 v[40:43], v3, s[8:11], s5 offen
    s_lshl_b32 s5, s97, 13
    s_lshr_b32 s6, s48, 4
    s_lshl_b32 s6, s6, 9
    s_add_u32 s5, s5, s6
    buffer_load_dwordx4 v[64:67], v5, s[20:23], s5 offen nt
    s_add_u32 s5, s5, 8192
    buffer_load_dwordx4 v[68:71], v5, s[20:23], s5 offen nt
    s_add_u32 s5, s5, 8192
    buffer_load_dwordx4 v[72:75], v5, s[20:23], s5 offen nt
    s_add_u32 s5, s5, 8192
    buffer_load_dwordx4 v[76:79], v5, s[20:23], s5 offen nt
    s_add_u32 s5, s5, 8192
    buffer_load_dwordx4 v[80:83], v5, s[20:23], s5 offen nt
    s_add_u32 s5, s5, 8192
    buffer_load_dwordx4 v[84:87], v5, s[20:23], s5 offen nt
    s_add_u32 s5, s5, 8192
    buffer_load_dwordx4 v[88:91], v5, s[20:23], s5 offen nt
    s_add_u32 s5, s5, 8192
    buffer_load_dwordx4 v[92:95], v5, s[20:23], s5 offen nt
L_pro2:
    s_mov_b32 s12, s66
    s_mov_b32 s13, s67
    s_mov_b32 s14, 67108864
    s_mov_b32 s15, 0x20000
    s_mov_b32 s16, s68
    s_mov_b32 s17, s69
    s_mov_b32 s18, 67108864
    s_mov_b32 s19, 0x20000
    s_mov_b32 s28, s76
    s_mov_b32 s29, s77
    s_mov_b32 s30, s55
    s_mov_b32 s31, 0x20000
    s_mov_b32 s32, s78
    s_mov_b32 s33, s79
    s_mov_b32 s34, s55
    s_mov_b32 s35, 0x20000
    s_mov_b32 s24, s72
    s_mov_b32 s25, s73
    s_mov_b32 s26, 8388608
    s_mov_b32 s27, 0x20000
    s_mov_b32 s36, s80
    s_mov_b32 s37, s81
    s_mov_b32 s38, s55
    s_mov_b32 s39, 0x20000
    s_mov_b32 s40, s82
    s_mov_b32 s41, s83
    s_mov_b32 s42, 2048
    s_mov_b32 s43, 0x20000
    s_mov_b32 s44, s86
    s_mov_b32 s45, s87
    s_mov_b32 s46, 268435456
    s_mov_b32 s47, 0x20000
    s_barrier
    s_lshr_b32 s88, s48, 4
    s_lshl_b32 s88, s88, 3
    s_and_b32 s5, s48, 7
    s_add_u32 s88, s88, s5
    s_cmp_ge_u32 s3, 4
    s_cbranch_scc1 L_helper
    s_mul_i32 s30, s50, 5767168
    s_and_b32 s30, s30, 0xff8000
    s_add_u32 s5, s4, 0
    s_xor_b32 s5, s5, s30
    buffer_load_dwordx4 v[64:67], v7, s[12:15], s5 offen offset:0 nt
    buffer_load_dwordx4 v[68:71], v7, s[12:15], s5 offen offset:128 nt
    s_xor_b32 s5, s5, 8192
    buffer_load_dwordx4 v[72:75], v7, s[12:15], s5 offen offset:0 nt
    buffer_load_dwordx4 v[76:79], v7, s[12:15], s5 offen offset:128 nt
    s_xor_b32 s5, s5, 24576
    buffer_load_dwordx4 v[80:83], v7, s[12:15], s5 offen offset:0 nt
    s_waitcnt vmcnt(4)
    buffer_load_dwordx4 v[84:87], v7, s[12:15], s5 offen offset:128 nt
    s_waitcnt vmcnt(4)
    s_xor_b32 s5, s5, 8192
    buffer_load_dwordx4 v[88:91], v7, s[12:15], s5 offen offset:0 nt
    s_waitcnt vmcnt(4)
    buffer_load_dwordx4 v[92:95], v7, s[12:15], s5 offen offset:128 nt
    s_waitcnt vmcnt(4)
    s_add_u32 s5, s4, 0
    s_xor_b32 s5, s5, s30
    buffer_load_dwordx4 v[96:99], v8, s[16:19], s5 offen offset:0 nt
    s_waitcnt vmcnt(4)
    buffer_load_dwordx4 v[100:103], v8, s[16:19], s5 offen offset:1024 nt
    s_waitcnt vmcnt(4)
    s_xor_b32 s5, s5, 8192
    buffer_load_dwordx4 v[104:107], v8, s[16:19], s5 offen offset:0 nt
    s_waitcnt vmcnt(4)
    buffer_load_dwordx4 v[108:111], v8, s[16:19], s5 offen offset:1024 nt
    s_waitcnt vmcnt(4)
    s_xor_b32 s5, s5, 24576
    buffer_load_dwordx4 v[112:115], v8, s[16:19], s5 offen offset:0 nt
    s_waitcnt vmcnt(4)
    buffer_load_dwordx4 v[116:119], v8, s[16:19], s5 offen offset:1024 nt
    s_waitcnt vmcnt(4)
    s_xor_b32 s5, s5, 8192
    buffer_load_dwordx4 v[120:123], v8, s[16:19], s5 offen offset:0 nt
    s_waitcnt vmcnt(4)
    buffer_load_dwordx4 v[124:127], v8, s[16:19], s5 offen offset:1024 nt
    s_waitcnt vmcnt(4)
    s_add_u32 s5, s4, 2097152
    s_xor_b32 s5, s5, s30
    buffer_load_dwordx4 v[128:131], v7, s[12:15], s5 offen offset:0 nt
    s_waitcnt vmcnt(4)
    buffer_load_dwordx4 v[132:135], v7, s[12:15], s5 offen offset:128 nt
    s_waitcnt vmcnt(4)
    s_xor_b32 s5, s5, 8192
    buffer_load_dwordx4 v[136:139], v7, s[12:15], s5 offen offset:0 nt
    s_waitcnt vmcnt(4)
    buffer_load_dwordx4 v[140:143], v7, s[12:15], s5 offen offset:128 nt
    s_waitcnt vmcnt(4)
    s_xor_b32 s5, s5, 24576
    buffer_load_dwordx4 v[144:147], v7, s[12:15], s5 offen offset:0 nt
    s_waitcnt vmcnt(4)
    buffer_load_dwordx4 v[148:151], v7, s[12:15], s5 offen offset:128 nt
    s_waitcnt vmcnt(4)
    s_xor_b32 s5, s5, 8192
    buffer_load_dwordx4 v[152:155], v7, s[12:15], s5 offen offset:0 nt
    s_waitcnt vmcnt(4)
    buffer_load_dwordx4 v[156:159], v7, s[12:15], s5 offen offset:128 nt
    s_waitcnt vmcnt(4)
    s_add_u32 s5, s4, 2097152
    s_xor_b32 s5, s5, s30
    buffer_load_dwordx4 v[160:163], v8, s[16:19], s5 offen offset:0 nt
    s_waitcnt vmcnt(4)
    buffer_load_dwordx4 v[164:167], v8, s[16:19], s5 offen offset:1024 nt
    s_waitcnt vmcnt(4)
    s_xor_b32 s5, s5, 8192
    buffer_load_dwordx4 v[168:171], v8, s[16:19], s5 offen offset:0 nt
    s_waitcnt vmcnt(4)
    buffer_load_dwordx4 v[172:175], v8, s[16:19], s5 offen offset:1024 nt
    s_waitcnt vmcnt(4)
    s_xor_b32 s5, s5, 24576
    buffer_load_dwordx4 v[176:179], v8, s[16:19], s5 offen offset:0 nt
    s_waitcnt vmcnt(4)
    buffer_load_dwordx4 v[180:183], v8, s[16:19], s5 offen offset:1024 nt
    s_waitcnt vmcnt(4)
    s_xor_b32 s5, s5, 8192
    buffer_load_dwordx4 v[184:187], v8, s[16:19], s5 offen offset:0 nt
    s_waitcnt vmcnt(4)
    buffer_load_dwordx4 v[188:191], v8, s[16:19], s5 offen offset:1024 nt
    s_waitcnt vmcnt(4)
    s_add_u32 s5, s4, 4194304
    s_xor_b32 s5, s5, s30
    buffer_load_dwordx4 v[192:195], v7, s[12:15], s5 offen offset:0 nt
    s_waitcnt vmcnt(4)
    buffer_load_dwordx4 v[196:199], v7, s[12:15], s5 offen offset:128 nt
    s_waitcnt vmcnt(4)
    s_xor_b32 s5, s5, 8192
    buffer_load_dwordx4 v[200:203], v7, s[12:15], s5 offen offset:0 nt
    s_waitcnt vmcnt(4)
    buffer_load_dwordx4 v[204:207], v7, s[12:15], s5 offen offset:128 nt
    s_waitcnt vmcnt(4)
    s_xor_b32 s5, s5, 24576
    buffer_load_dwordx4 v[208:211], v7, s[12:15], s5 offen offset:0 nt
    s_mov_b64 exec, 1
    ds_add_u32 v14, v15 offset:44
    s_mov_b64 exec, -1
    s_waitcnt vmcnt(4)
    buffer_load_dwordx4 v[212:215], v7, s[12:15], s5 offen offset:128 nt
    s_waitcnt vmcnt(4)
    s_xor_b32 s5, s5, 8192
    buffer_load_dwordx4 v[216:219], v7, s[12:15], s5 offen offset:0 nt
    s_waitcnt vmcnt(4)
    buffer_load_dwordx4 v[220:223], v7, s[12:15], s5 offen offset:128 nt
    s_waitcnt vmcnt(4)
    s_add_u32 s5, s4, 4194304
    s_xor_b32 s5, s5, s30
    buffer_load_dwordx4 v[224:227], v8, s[16:19], s5 offen offset:0 nt
    s_waitcnt vmcnt(4)
    buffer_load_dwordx4 v[228:231], v8, s[16:19], s5 offen offset:1024 nt
    s_waitcnt vmcnt(4)
    s_xor_b32 s5, s5, 8192
    buffer_load_dwordx4 v[232:235], v8, s[16:19], s5 offen offset:0 nt
    s_waitcnt vmcnt(4)
    buffer_load_dwordx4 v[236:239], v8, s[16:19], s5 offen offset:1024 nt
    s_waitcnt vmcnt(4)
    s_xor_b32 s5, s5, 24576
    buffer_load_dwordx4 v[240:243], v8, s[16:19], s5 offen offset:0 nt
    s_waitcnt vmcnt(4)
    buffer_load_dwordx4 v[244:247], v8, s[16:19], s5 offen offset:1024 nt
    s_waitcnt vmcnt(4)
    s_xor_b32 s5, s5, 8192
    buffer_load_dwordx4 v[248:251], v8, s[16:19], s5 offen offset:0 nt
    s_waitcnt vmcnt(4)
    buffer_load_dwordx4 v[252:255], v8, s[16:19], s5 offen offset:1024 nt
    s_lshl_b32 s22, s54, 14
    s_add_u32 s22, s22, 37888
    s_waitcnt vmcnt(4)
    s_add_u32 m0, s22, 0
    s_add_u32 s5, s4, 6291456
    s_xor_b32 s5, s5, s30
    buffer_load_dwordx4 v7, s[12:15], s5 offen offset:0 nt lds
    s_waitcnt vmcnt(4)
    s_add_u32 m0, s22, 896
    s_nop 0
    buffer_load_dwordx4 v7, s[12:15], s5 offen offset:128 nt lds
    s_waitcnt vmcnt(4)
    s_add_u32 m0, s22, 2048
    s_xor_b32 s5, s5, 8192
    buffer_load_dwordx4 v7, s[12:15], s5 offen offset:0 nt lds
    s_waitcnt vmcnt(4)
    s_add_u32 m0, s22, 2944
    s_nop 0
    buffer_load_dwordx4 v7, s[12:15], s5 offen offset:128 nt lds
    s_waitcnt vmcnt(4)
    s_add_u32 m0, s22, 4096
    s_xor_b32 s5, s5, 24576
    buffer_load_dwordx4 v7, s[12:15], s5 offen offset:0 nt lds
    s_waitcnt vmcnt(4)
    s_add_u32 m0, s22, 4992
    s_nop 0
    buffer_load_dwordx4 v7, s[12:15], s5 offen offset:128 nt lds
    s_waitcnt vmcnt(4)
    s_add_u32 m0, s22, 6144
    s_xor_b32 s5, s5, 8192
    buffer_load_dwordx4 v7, s[12:15], s5 offen offset:0 nt lds
    s_waitcnt vmcnt(4)
    s_add_u32 m0, s22, 7040
    s_nop 0
    buffer_load_dwordx4 v7, s[12:15], s5 offen offset:128 nt lds
    s_waitcnt vmcnt(4)
    s_add_u32 m0, s22, 8192
    s_add_u32 s5, s4, 6291456
    s_xor_b32 s5, s5, s30
    buffer_load_dwordx4 v8, s[16:19], s5 offen offset:0 nt lds
    s_waitcnt vmcnt(4)
    s_add_u32 m0, s22, 8192
    s_nop 0
    buffer_load_dwordx4 v8, s[16:19], s5 offen offset:1024 nt lds
    s_waitcnt vmcnt(4)
    s_add_u32 m0, s22, 10240
    s_xor_b32 s5, s5, 8192
    buffer_load_dwordx4 v8, s[16:19], s5 offen offset:0 nt lds
    s_waitcnt vmcnt(4)
    s_add_u32 m0, s22, 10240
    s_nop 0
    buffer_load_dwordx4 v8, s[16:19], s5 offen offset:1024 nt lds
    s_waitcnt vmcnt(4)
    s_add_u32 m0, s22, 12288
    s_xor_b32 s5, s5, 24576
    buffer_load_dwordx4 v8, s[16:19], s5 offen offset:0 nt lds
    s_waitcnt vmcnt(4)
    s_add_u32 m0, s22, 12288
    s_nop 0
    buffer_load_dwordx4 v8, s[16:19], s5 offen offset:1024 nt lds
    s_waitcnt vmcnt(4)
    s_add_u32 m0, s22, 14336
    s_xor_b32 s5, s5, 8192
    buffer_load_dwordx4 v8, s[16:19], s5 offen offset:0 nt lds
    s_waitcnt vmcnt(4)
    s_add_u32 m0, s22, 14336
    s_nop 0
    buffer_load_dwordx4 v8, s[16:19], s5 offen offset:1024 nt lds
    v_add_u32 v0, s22, v8
    v_and_b32 v5, 7, v1
    s_lshl_b32 s5, s54, 3
    v_lshlrev_b32 v12, 5, v5
    v_add_u32 v12, s5, v12
    s_movk_i32 s56, 528
    v_mul_u32_u24 v11, s56, v5
    v_lshl_add_u32 v11, v9, 7, v11
    s_mul_i32 s5, s54, 4224
    v_add_u32 v11, s5, v11
    v_lshrrev_b32 v2, 5, v1
    v_mul_u32_u24 v6, s56, v2
    v_and_b32 v3, 31, v1
    v_lshl_add_u32 v6, v3, 4, v6
    s_mul_i32 s5, s54, 1056
    v_add_u32 v6, s5, v6
    v_lshl_add_u32 v3, v9, 3, v5
    v_lshlrev_b32 v3, 4, v3
    s_lshl_b32 s56, s54, 2
    v_add_u32 v3, s56, v3
    s_lshl_b32 s5, s54, 6
    v_lshl_add_u32 v5, v2, 5, s5
    v_lshrrev_b32 v2, 3, v1
    v_lshl_add_u32 v4, v2, 13, v4
    s_lshl_b32 s92, s50, 18
    s_lshl_b32 s6, s54, 16
    s_add_u32 s92, s92, s6
    s_lshl_b32 s7, s51, 7
    s_add_u32 s92, s92, s7
    s_add_u32 s92, s92, 1048576
    s_lshl_b32 s93, s88, 13
    s_lshl_b32 s6, s54, 11
    s_add_u32 s93, s93, s6
    s_add_u32 s93, s93, 1048576
    s_lshr_b32 s5, s48, 4
    s_mul_i32 s5, s5, 4352
    s_add_u32 s5, s5, 3145728
    s_add_u32 s98, s86, s5
    s_addc_u32 s99, s87, 0
    s_lshr_b32 s5, s51, 4
    s_mul_i32 s5, s5, 524288
    s_lshl_b32 s26, s50, 24
    s_add_u32 s26, s26, s5
    s_add_u32 s26, s26, 14680064
    s_add_u32 s21, s4, 10485760
    s_mov_b32 s23, 6
    s_mov_b32 s24, 0
    s_mov_b32 s29, -1
    s_cmp_eq_u32 s54, 0
    s_cselect_b32 s29, 32, s29
    s_cmp_eq_u32 s54, 1
    s_cselect_b32 s29, 32, s29
    s_cmp_eq_u32 s54, 2
    s_cselect_b32 s29, 1, s29
    s_cmp_eq_u32 s54, 3
    s_cselect_b32 s29, 1, s29
    s_mov_b32 s27, 0
    s_mov_b32 s25, 0
    v_and_b32 v46, 7, v1
    v_lshlrev_b32 v46, 8, v46
    v_lshl_add_u32 v46, v9, 5, v46
    v_and_b32 v45, 8, v1
    v_lshl_add_u32 v46, v45, 1, v46
    s_mov_b32 s58, 4000000
L_sp1:
    ds_read_b32 v47, v14 offset:8
    s_sub_u32 s58, s58, 1
    s_cbranch_scc1 L_end
    s_waitcnt lgkmcnt(0)
    v_readfirstlane_b32 s56, v47
    s_nop 0
    s_cmp_eq_u32 s56, 1
    s_cbranch_scc1 L_sd1
    s_sleep 1
    s_branch L_sp1
L_sd1:
    ds_read_b128 v[16:19], v46 offset:4096
    ds_read_b128 v[20:23], v46 offset:4224
    ds_read_b32 v2, v14 offset:192
    s_waitcnt lgkmcnt(0)
    v_readfirstlane_b32 s49, v2
    s_nop 0
    s_and_b32 s89, s49, 0xffff
    s_waitcnt lgkmcnt(0)
    v_mfma_f32_16x16x32_bf16 v[24:27], v[64:67], v[16:19], 0
    v_mfma_f32_16x16x32_bf16 v[24:27], v[68:71], v[20:23], v[24:27]
    v_mfma_f32_16x16x32_bf16 v[28:31], v[72:75], v[16:19], 0
    v_mfma_f32_16x16x32_bf16 v[28:31], v[76:79], v[20:23], v[28:31]
    v_mfma_f32_16x16x32_bf16 v[32:35], v[80:83], v[16:19], 0
    v_mfma_f32_16x16x32_bf16 v[32:35], v[84:87], v[20:23], v[32:35]
    v_mfma_f32_16x16x32_bf16 v[36:39], v[88:91], v[16:19], 0
    v_mfma_f32_16x16x32_bf16 v[36:39], v[92:95], v[20:23], v[36:39]
    s_nop 1
    v_add_f32_dpp v48, v25, v24 row_ror:8 row_mask:0xf bank_mask:0xf
    v_add_f32_dpp v49, v27, v26 row_ror:8 row_mask:0xf bank_mask:0xf
    v_cvt_pk_bf16_f32 v46, v48, v49
    v_lshlrev_b32 v48, 16, v46
    v_and_b32 v49, s62, v46
    v_mul_f32 v48, s59, v48
    v_mul_f32 v49, s59, v49
    v_cvt_pk_bf16_f32 v46, v48, v49
    v_lshlrev_b32 v48, 16, v46
    v_and_b32 v49, s62, v46
    v_max_f32 v47, v48, v49
    v_add_f32_dpp v50, v29, v28 row_ror:8 row_mask:0xf bank_mask:0xf
    v_add_f32_dpp v51, v31, v30 row_ror:8 row_mask:0xf bank_mask:0xf
    v_cvt_pk_bf16_f32 v46, v50, v51
    v_lshlrev_b32 v50, 16, v46
    v_and_b32 v51, s62, v46
    v_mul_f32 v50, s59, v50
    v_mul_f32 v51, s59, v51
    v_cvt_pk_bf16_f32 v46, v50, v51
    v_lshlrev_b32 v50, 16, v46
    v_and_b32 v51, s62, v46
    v_max3_f32 v47, v47, v50, v51
    v_add_f32_dpp v52, v33, v32 row_ror:8 row_mask:0xf bank_mask:0xf
    v_add_f32_dpp v53, v35, v34 row_ror:8 row_mask:0xf bank_mask:0xf
    v_cvt_pk_bf16_f32 v46, v52, v53
    v_lshlrev_b32 v52, 16, v46
    v_and_b32 v53, s62, v46
    v_mul_f32 v52, s59, v52
    v_mul_f32 v53, s59, v53
    v_cvt_pk_bf16_f32 v46, v52, v53
    v_lshlrev_b32 v52, 16, v46
    v_and_b32 v53, s62, v46
    v_max3_f32 v47, v47, v52, v53
    v_add_f32_dpp v54, v37, v36 row_ror:8 row_mask:0xf bank_mask:0xf
    v_add_f32_dpp v55, v39, v38 row_ror:8 row_mask:0xf bank_mask:0xf
    v_cvt_pk_bf16_f32 v46, v54, v55
    v_lshlrev_b32 v54, 16, v46
    v_and_b32 v55, s62, v46
    v_mul_f32 v54, s59, v54
    v_mul_f32 v55, s59, v55
    v_cvt_pk_bf16_f32 v46, v54, v55
    v_lshlrev_b32 v54, 16, v46
    v_and_b32 v55, s62, v46
    v_max3_f32 v47, v47, v54, v55
    v_mov_b32 v46, v47
    s_nop 1
    v_permlane16_swap_b32 v47, v46
    v_max_f32 v47, v47, v46
    v_mov_b32 v46, v47
    s_nop 1
    v_permlane32_swap_b32 v47, v46
    v_max_f32 v47, v47, v46
    v_mov_b32 v44, v47
    v_mul_f32 v47, s63, v47
    v_fma_f32 v48, v48, s63, -v47
    v_fma_f32 v49, v49, s63, -v47
    v_fma_f32 v50, v50, s63, -v47
    v_fma_f32 v51, v51, s63, -v47
    v_fma_f32 v52, v52, s63, -v47
    v_fma_f32 v53, v53, s63, -v47
    v_fma_f32 v54, v54, s63, -v47
    v_fma_f32 v55, v55, s63, -v47
    v_exp_f32 v48, v48
    v_exp_f32 v49, v49
    v_exp_f32 v50, v50
    v_exp_f32 v51, v51
    v_exp_f32 v52, v52
    v_exp_f32 v53, v53
    v_exp_f32 v54, v54
    v_exp_f32 v55, v55
    v_mov_b32 v45, v48
    v_add_f32 v45, v45, v49
    v_add_f32 v45, v45, v50
    v_add_f32 v45, v45, v51
    v_add_f32 v45, v45, v52
    v_add_f32 v45, v45, v53
    v_add_f32 v45, v45, v54
    v_add_f32 v45, v45, v55
    v_cvt_pk_bf16_f32 v40, v48, v49
    v_cvt_pk_bf16_f32 v41, v50, v51
    v_cvt_pk_bf16_f32 v42, v52, v53
    v_cvt_pk_bf16_f32 v43, v54, v55
    v_perm_b32 v48, v100, v96, s60
    v_perm_b32 v49, v108, v104, s60
    v_perm_b32 v50, v116, v112, s60
    v_perm_b32 v51, v124, v120, s60
    s_nop 1
    v_mfma_f32_16x16x32_bf16 v[64:67], v[48:51], v[40:43], 0
    v_perm_b32 v52, v100, v96, s61
    v_perm_b32 v53, v108, v104, s61
    v_perm_b32 v54, v116, v112, s61
    v_perm_b32 v55, v124, v120, s61
    s_nop 1
    v_mfma_f32_16x16x32_bf16 v[68:71], v[52:55], v[40:43], 0
    v_perm_b32 v56, v101, v97, s60
    v_perm_b32 v57, v109, v105, s60
    v_perm_b32 v58, v117, v113, s60
    v_perm_b32 v59, v125, v121, s60
    s_nop 1
    v_mfma_f32_16x16x32_bf16 v[72:75], v[56:59], v[40:43], 0
    v_perm_b32 v60, v101, v97, s61
    v_perm_b32 v61, v109, v105, s61
    v_perm_b32 v62, v117, v113, s61
    v_perm_b32 v63, v125, v121, s61
    s_nop 1
    v_mfma_f32_16x16x32_bf16 v[76:79], v[60:63], v[40:43], 0
    v_perm_b32 v48, v102, v98, s60
    v_perm_b32 v49, v110, v106, s60
    v_perm_b32 v50, v118, v114, s60
    v_perm_b32 v51, v126, v122, s60
    s_nop 1
    v_mfma_f32_16x16x32_bf16 v[80:83], v[48:51], v[40:43], 0
    v_perm_b32 v52, v102, v98, s61
    v_perm_b32 v53, v110, v106, s61
    v_perm_b32 v54, v118, v114, s61
    v_perm_b32 v55, v126, v122, s61
    s_nop 1
    v_mfma_f32_16x16x32_bf16 v[84:87], v[52:55], v[40:43], 0
    v_perm_b32 v56, v103, v99, s60
    v_perm_b32 v57, v111, v107, s60
    v_perm_b32 v58, v119, v115, s60
    v_perm_b32 v59, v127, v123, s60
    s_nop 1
    v_mfma_f32_16x16x32_bf16 v[88:91], v[56:59], v[40:43], 0
    v_perm_b32 v60, v103, v99, s61
    v_perm_b32 v61, v111, v107, s61
    v_perm_b32 v62, v119, v115, s61
    v_perm_b32 v63, v127, v123, s61
    s_nop 1
    v_mfma_f32_16x16x32_bf16 v[92:95], v[60:63], v[40:43], 0
    s_waitcnt vmcnt(8)
    s_waitcnt vmcnt(7)
    s_add_u32 s5, s4, 8388608
    s_xor_b32 s5, s5, s30
    buffer_load_dwordx4 v[96:99], v7, s[12:15], s5 offen offset:0 nt
    v_mfma_f32_16x16x32_bf16 v[24:27], v[128:131], v[16:19], 0
    v_mfma_f32_16x16x32_bf16 v[24:27], v[132:135], v[20:23], v[24:27]
    v_mfma_f32_16x16x32_bf16 v[28:31], v[136:139], v[16:19], 0
    v_mfma_f32_16x16x32_bf16 v[28:31], v[140:143], v[20:23], v[28:31]
    v_mfma_f32_16x16x32_bf16 v[32:35], v[144:147], v[16:19], 0
    v_mfma_f32_16x16x32_bf16 v[32:35], v[148:151], v[20:23], v[32:35]
    v_mfma_f32_16x16x32_bf16 v[36:39], v[152:155], v[16:19], 0
    v_mfma_f32_16x16x32_bf16 v[36:39], v[156:159], v[20:23], v[36:39]
    s_nop 1
    v_add_f32_dpp v48, v25, v24 row_ror:8 row_mask:0xf bank_mask:0xf
    v_add_f32_dpp v49, v27, v26 row_ror:8 row_mask:0xf bank_mask:0xf
    v_cvt_pk_bf16_f32 v46, v48, v49
    v_lshlrev_b32 v48, 16, v46
    v_and_b32 v49, s62, v46
    v_mul_f32 v48, s59, v48
    v_mul_f32 v49, s59, v49
    v_cvt_pk_bf16_f32 v46, v48, v49
    v_lshlrev_b32 v48, 16, v46
    v_and_b32 v49, s62, v46
    v_max3_f32 v47, v44, v48, v49
    v_add_f32_dpp v50, v29, v28 row_ror:8 row_mask:0xf bank_mask:0xf
    v_add_f32_dpp v51, v31, v30 row_ror:8 row_mask:0xf bank_mask:0xf
    s_waitcnt vmcnt(7)
    buffer_load_dwordx4 v[100:103], v7, s[12:15], s5 offen offset:128 nt
    v_cvt_pk_bf16_f32 v46, v50, v51
    v_lshlrev_b32 v50, 16, v46
    v_and_b32 v51, s62, v46
    v_mul_f32 v50, s59, v50
    v_mul_f32 v51, s59, v51
    v_cvt_pk_bf16_f32 v46, v50, v51
    v_lshlrev_b32 v50, 16, v46
    v_and_b32 v51, s62, v46
    v_max3_f32 v47, v47, v50, v51
    v_add_f32_dpp v52, v33, v32 row_ror:8 row_mask:0xf bank_mask:0xf
    v_add_f32_dpp v53, v35, v34 row_ror:8 row_mask:0xf bank_mask:0xf
    v_cvt_pk_bf16_f32 v46, v52, v53
    v_lshlrev_b32 v52, 16, v46
    v_and_b32 v53, s62, v46
    v_mul_f32 v52, s59, v52
    v_mul_f32 v53, s59, v53
    v_cvt_pk_bf16_f32 v46, v52, v53
    v_lshlrev_b32 v52, 16, v46
    v_and_b32 v53, s62, v46
    v_max3_f32 v47, v47, v52, v53
    s_waitcnt vmcnt(7)
    s_xor_b32 s5, s5, 8192
    buffer_load_dwordx4 v[104:107], v7, s[12:15], s5 offen offset:0 nt
    v_add_f32_dpp v54, v37, v36 row_ror:8 row_mask:0xf bank_mask:0xf
    v_add_f32_dpp v55, v39, v38 row_ror:8 row_mask:0xf bank_mask:0xf
    v_cvt_pk_bf16_f32 v46, v54, v55
    v_lshlrev_b32 v54, 16, v46
    v_and_b32 v55, s62, v46
    v_mul_f32 v54, s59, v54
    v_mul_f32 v55, s59, v55
    v_cvt_pk_bf16_f32 v46, v54, v55
    v_lshlrev_b32 v54, 16, v46
    v_and_b32 v55, s62, v46
    v_max3_f32 v47, v47, v54, v55
    v_mov_b32 v46, v47
    s_nop 1
    v_permlane16_swap_b32 v47, v46
    v_max_f32 v47, v47, v46
    v_mov_b32 v46, v47
    s_nop 1
    v_permlane32_swap_b32 v47, v46
    v_max_f32 v47, v47, v46
    v_sub_f32 v46, v44, v47
    v_mul_f32 v46, s63, v46
    v_exp_f32 v46, v46
    v_mov_b32 v44, v47
    s_waitcnt vmcnt(7)
    buffer_load_dwordx4 v[108:111], v7, s[12:15], s5 offen offset:128 nt
    v_mul_f32 v47, s63, v47
    v_fma_f32 v48, v48, s63, -v47
    v_fma_f32 v49, v49, s63, -v47
    v_fma_f32 v50, v50, s63, -v47
    v_fma_f32 v51, v51, s63, -v47
    v_fma_f32 v52, v52, s63, -v47
    v_fma_f32 v53, v53, s63, -v47
    v_fma_f32 v54, v54, s63, -v47
    v_fma_f32 v55, v55, s63, -v47
    v_exp_f32 v48, v48
    v_exp_f32 v49, v49
    v_exp_f32 v50, v50
    v_exp_f32 v51, v51
    v_exp_f32 v52, v52
    v_exp_f32 v53, v53
    v_exp_f32 v54, v54
    v_exp_f32 v55, v55
    v_fma_f32 v45, v45, v46, v48
    v_mul_f32 v64, v46, v64
    v_mul_f32 v65, v46, v65
    s_waitcnt vmcnt(7)
    s_xor_b32 s5, s5, 24576
    buffer_load_dwordx4 v[112:115], v7, s[12:15], s5 offen offset:0 nt
    v_mul_f32 v66, v46, v66
    v_mul_f32 v67, v46, v67
    v_mul_f32 v68, v46, v68
    v_mul_f32 v69, v46, v69
    v_mul_f32 v70, v46, v70
    v_mul_f32 v71, v46, v71
    v_mul_f32 v72, v46, v72
    v_mul_f32 v73, v46, v73
    v_mul_f32 v74, v46, v74
    v_mul_f32 v75, v46, v75
    v_mul_f32 v76, v46, v76
    v_mul_f32 v77, v46, v77
    v_mul_f32 v78, v46, v78
    v_mul_f32 v79, v46, v79
    v_mul_f32 v80, v46, v80
    v_mul_f32 v81, v46, v81
    v_mul_f32 v82, v46, v82
    v_mul_f32 v83, v46, v83
    v_mul_f32 v84, v46, v84
    v_mul_f32 v85, v46, v85
    s_waitcnt vmcnt(7)
    buffer_load_dwordx4 v[116:119], v7, s[12:15], s5 offen offset:128 nt
    v_mul_f32 v86, v46, v86
    v_mul_f32 v87, v46, v87
    v_mul_f32 v88, v46, v88
    v_mul_f32 v89, v46, v89
    v_mul_f32 v90, v46, v90
    v_mul_f32 v91, v46, v91
    v_mul_f32 v92, v46, v92
    v_mul_f32 v93, v46, v93
    v_mul_f32 v94, v46, v94
    v_mul_f32 v95, v46, v95
    v_add_f32 v45, v45, v49
    v_add_f32 v45, v45, v50
    v_add_f32 v45, v45, v51
    v_add_f32 v45, v45, v52
    v_add_f32 v45, v45, v53
    v_add_f32 v45, v45, v54
    v_add_f32 v45, v45, v55
    v_cvt_pk_bf16_f32 v40, v48, v49
    v_cvt_pk_bf16_f32 v41, v50, v51
    v_cvt_pk_bf16_f32 v42, v52, v53
    v_cvt_pk_bf16_f32 v43, v54, v55
    s_waitcnt vmcnt(7)
    s_xor_b32 s5, s5, 8192
    buffer_load_dwordx4 v[120:123], v7, s[12:15], s5 offen offset:0 nt
    v_perm_b32 v48, v164, v160, s60
    v_perm_b32 v49, v172, v168, s60
    v_perm_b32 v50, v180, v176, s60
    v_perm_b32 v51, v188, v184, s60
    s_nop 1
    v_mfma_f32_16x16x32_bf16 v[64:67], v[48:51], v[40:43], v[64:67]
    v_perm_b32 v52, v164, v160, s61
    v_perm_b32 v53, v172, v168, s61
    v_perm_b32 v54, v180, v176, s61
    v_perm_b32 v55, v188, v184, s61
    s_nop 1
    v_mfma_f32_16x16x32_bf16 v[68:71], v[52:55], v[40:43], v[68:71]
    v_perm_b32 v56, v165, v161, s60
    v_perm_b32 v57, v173, v169, s60
    v_perm_b32 v58, v181, v177, s60
    v_perm_b32 v59, v189, v185, s60
    s_nop 1
    v_mfma_f32_16x16x32_bf16 v[72:75], v[56:59], v[40:43], v[72:75]
    v_perm_b32 v60, v165, v161, s61
    v_perm_b32 v61, v173, v169, s61
    v_perm_b32 v62, v181, v177, s61
    v_perm_b32 v63, v189, v185, s61
    s_nop 1
    v_mfma_f32_16x16x32_bf16 v[76:79], v[60:63], v[40:43], v[76:79]
    s_waitcnt vmcnt(7)
    buffer_load_dwordx4 v[124:127], v7, s[12:15], s5 offen offset:128 nt
    v_perm_b32 v48, v166, v162, s60
    v_perm_b32 v49, v174, v170, s60
    v_perm_b32 v50, v182, v178, s60
    v_perm_b32 v51, v190, v186, s60
    s_nop 1
    v_mfma_f32_16x16x32_bf16 v[80:83], v[48:51], v[40:43], v[80:83]
    v_perm_b32 v52, v166, v162, s61
    v_perm_b32 v53, v174, v170, s61
    v_perm_b32 v54, v182, v178, s61
    v_perm_b32 v55, v190, v186, s61
    s_nop 1
    v_mfma_f32_16x16x32_bf16 v[84:87], v[52:55], v[40:43], v[84:87]
    v_perm_b32 v56, v167, v163, s60
    v_perm_b32 v57, v175, v171, s60
    v_perm_b32 v58, v183, v179, s60
    v_perm_b32 v59, v191, v187, s60
    s_nop 1
    v_mfma_f32_16x16x32_bf16 v[88:91], v[56:59], v[40:43], v[88:91]
    v_perm_b32 v60, v167, v163, s61
    v_perm_b32 v61, v175, v171, s61
    v_perm_b32 v62, v183, v179, s61
    v_perm_b32 v63, v191, v187, s61
    s_nop 1
    v_mfma_f32_16x16x32_bf16 v[92:95], v[60:63], v[40:43], v[92:95]
    s_waitcnt vmcnt(8)
    s_waitcnt vmcnt(7)
    s_add_u32 s5, s4, 8388608
    s_xor_b32 s5, s5, s30
    buffer_load_dwordx4 v[128:131], v8, s[16:19], s5 offen offset:0 nt
    ds_read_b128 v[160:163], v0 offset:0
    ds_read_b128 v[164:167], v0 offset:1024
    ds_read_b128 v[168:171], v0 offset:2048
    ds_read_b128 v[172:175], v0 offset:3072
    ds_read_b128 v[176:179], v0 offset:4096
    ds_read_b128 v[180:183], v0 offset:5120
    ds_read_b128 v[184:187], v0 offset:6144
    ds_read_b128 v[188:191], v0 offset:7168
    v_mfma_f32_16x16x32_bf16 v[24:27], v[192:195], v[16:19], 0
    v_mfma_f32_16x16x32_bf16 v[24:27], v[196:199], v[20:23], v[24:27]
    v_mfma_f32_16x16x32_bf16 v[28:31], v[200:203], v[16:19], 0
    v_mfma_f32_16x16x32_bf16 v[28:31], v[204:207], v[20:23], v[28:31]
    v_mfma_f32_16x16x32_bf16 v[32:35], v[208:211], v[16:19], 0
    v_mfma_f32_16x16x32_bf16 v[32:35], v[212:215], v[20:23], v[32:35]
    v_mfma_f32_16x16x32_bf16 v[36:39], v[216:219], v[16:19], 0
    v_mfma_f32_16x16x32_bf16 v[36:39], v[220:223], v[20:23], v[36:39]
    s_nop 1
    v_add_f32_dpp v48, v25, v24 row_ror:8 row_mask:0xf bank_mask:0xf
    v_add_f32_dpp v49, v27, v26 row_ror:8 row_mask:0xf bank_mask:0xf
    v_cvt_pk_bf16_f32 v46, v48, v49
    v_lshlrev_b32 v48, 16, v46
    v_and_b32 v49, s62, v46
    v_mul_f32 v48, s59, v48
    v_mul_f32 v49, s59, v49
    v_cvt_pk_bf16_f32 v46, v48, v49
    v_lshlrev_b32 v48, 16, v46
    v_and_b32 v49, s62, v46
    v_max3_f32 v47, v44, v48, v49
    v_add_f32_dpp v50, v29, v28 row_ror:8 row_mask:0xf bank_mask:0xf
    v_add_f32_dpp v51, v31, v30 row_ror:8 row_mask:0xf bank_mask:0xf
    v_cvt_pk_bf16_f32 v46, v50, v51
    v_lshlrev_b32 v50, 16, v46
    v_and_b32 v51, s62, v46
    v_mul_f32 v50, s59, v50
    v_mul_f32 v51, s59, v51
    v_cvt_pk_bf16_f32 v46, v50, v51
    v_lshlrev_b32 v50, 16, v46
    v_and_b32 v51, s62, v46
    v_max3_f32 v47, v47, v50, v51
    v_add_f32_dpp v52, v33, v32 row_ror:8 row_mask:0xf bank_mask:0xf
    v_add_f32_dpp v53, v35, v34 row_ror:8 row_mask:0xf bank_mask:0xf
    v_cvt_pk_bf16_f32 v46, v52, v53
    v_lshlrev_b32 v52, 16, v46
    v_and_b32 v53, s62, v46
    s_waitcnt vmcnt(7)
    buffer_load_dwordx4 v[132:135], v8, s[16:19], s5 offen offset:1024 nt
    v_mul_f32 v52, s59, v52
    v_mul_f32 v53, s59, v53
    v_cvt_pk_bf16_f32 v46, v52, v53
    v_lshlrev_b32 v52, 16, v46
    v_and_b32 v53, s62, v46
    v_max3_f32 v47, v47, v52, v53
    v_add_f32_dpp v54, v37, v36 row_ror:8 row_mask:0xf bank_mask:0xf
    v_add_f32_dpp v55, v39, v38 row_ror:8 row_mask:0xf bank_mask:0xf
    v_cvt_pk_bf16_f32 v46, v54, v55
    v_lshlrev_b32 v54, 16, v46
    v_and_b32 v55, s62, v46
    v_mul_f32 v54, s59, v54
    v_mul_f32 v55, s59, v55
    v_cvt_pk_bf16_f32 v46, v54, v55
    v_lshlrev_b32 v54, 16, v46
    v_and_b32 v55, s62, v46
    v_max3_f32 v47, v47, v54, v55
    v_mov_b32 v46, v47
    s_nop 1
    v_permlane16_swap_b32 v47, v46
    v_max_f32 v47, v47, v46
    v_mov_b32 v46, v47
    s_nop 1
    v_permlane32_swap_b32 v47, v46
    v_max_f32 v47, v47, v46
    v_sub_f32 v46, v44, v47
    v_mul_f32 v46, s63, v46
    v_exp_f32 v46, v46
    v_mov_b32 v44, v47
    v_mul_f32 v47, s63, v47
    v_fma_f32 v48, v48, s63, -v47
    v_fma_f32 v49, v49, s63, -v47
    v_fma_f32 v50, v50, s63, -v47
    v_fma_f32 v51, v51, s63, -v47
    v_fma_f32 v52, v52, s63, -v47
    v_fma_f32 v53, v53, s63, -v47
    v_fma_f32 v54, v54, s63, -v47
    v_fma_f32 v55, v55, s63, -v47
    v_exp_f32 v48, v48
    v_exp_f32 v49, v49
    v_exp_f32 v50, v50
    v_exp_f32 v51, v51
    v_exp_f32 v52, v52
    v_exp_f32 v53, v53
    v_exp_f32 v54, v54
    s_waitcnt vmcnt(7)
    s_xor_b32 s5, s5, 8192
    buffer_load_dwordx4 v[136:139], v8, s[16:19], s5 offen offset:0 nt
    v_exp_f32 v55, v55
    v_fma_f32 v45, v45, v46, v48
    v_mul_f32 v64, v46, v64
    v_mul_f32 v65, v46, v65
    v_mul_f32 v66, v46, v66
    v_mul_f32 v67, v46, v67
    v_mul_f32 v68, v46, v68
    v_mul_f32 v69, v46, v69
    v_mul_f32 v70, v46, v70
    v_mul_f32 v71, v46, v71
    v_mul_f32 v72, v46, v72
    v_mul_f32 v73, v46, v73
    v_mul_f32 v74, v46, v74
    v_mul_f32 v75, v46, v75
    v_mul_f32 v76, v46, v76
    v_mul_f32 v77, v46, v77
    v_mul_f32 v78, v46, v78
    v_mul_f32 v79, v46, v79
    v_mul_f32 v80, v46, v80
    v_mul_f32 v81, v46, v81
    v_mul_f32 v82, v46, v82
    v_mul_f32 v83, v46, v83
    v_mul_f32 v84, v46, v84
    v_mul_f32 v85, v46, v85
    v_mul_f32 v86, v46, v86
    v_mul_f32 v87, v46, v87
    v_mul_f32 v88, v46, v88
    v_mul_f32 v89, v46, v89
    v_mul_f32 v90, v46, v90
    v_mul_f32 v91, v46, v91
    v_mul_f32 v92, v46, v92
    v_mul_f32 v93, v46, v93
    v_mul_f32 v94, v46, v94
    v_mul_f32 v95, v46, v95
    v_add_f32 v45, v45, v49
    v_add_f32 v45, v45, v50
    v_add_f32 v45, v45, v51
    v_add_f32 v45, v45, v52
    v_add_f32 v45, v45, v53
    v_add_f32 v45, v45, v54
    v_add_f32 v45, v45, v55
    v_cvt_pk_bf16_f32 v40, v48, v49
    v_cvt_pk_bf16_f32 v41, v50, v51
    s_waitcnt vmcnt(7)
    buffer_load_dwordx4 v[140:143], v8, s[16:19], s5 offen offset:1024 nt
    v_cvt_pk_bf16_f32 v42, v52, v53
    v_cvt_pk_bf16_f32 v43, v54, v55
    ds_read_b128 v[192:195], v0 offset:8192
    ds_read_b128 v[196:199], v0 offset:9216
    ds_read_b128 v[200:203], v0 offset:10240
    ds_read_b128 v[204:207], v0 offset:11264
    ds_read_b128 v[208:211], v0 offset:12288
    ds_read_b128 v[212:215], v0 offset:13312
    ds_read_b128 v[216:219], v0 offset:14336
    ds_read_b128 v[220:223], v0 offset:15360
    v_perm_b32 v48, v228, v224, s60
    v_perm_b32 v49, v236, v232, s60
    v_perm_b32 v50, v244, v240, s60
    v_perm_b32 v51, v252, v248, s60
    s_nop 1
    v_mfma_f32_16x16x32_bf16 v[64:67], v[48:51], v[40:43], v[64:67]
    v_perm_b32 v52, v228, v224, s61
    v_perm_b32 v53, v236, v232, s61
    v_perm_b32 v54, v244, v240, s61
    v_perm_b32 v55, v252, v248, s61
    s_nop 1
    v_mfma_f32_16x16x32_bf16 v[68:71], v[52:55], v[40:43], v[68:71]
    v_perm_b32 v56, v229, v225, s60
    v_perm_b32 v57, v237, v233, s60
    v_perm_b32 v58, v245, v241, s60
    v_perm_b32 v59, v253, v249, s60
    s_nop 1
    v_mfma_f32_16x16x32_bf16 v[72:75], v[56:59], v[40:43], v[72:75]
    v_perm_b32 v60, v229, v225, s61
    v_perm_b32 v61, v237, v233, s61
    v_perm_b32 v62, v245, v241, s61
    v_perm_b32 v63, v253, v249, s61
    s_nop 1
    v_mfma_f32_16x16x32_bf16 v[76:79], v[60:63], v[40:43], v[76:79]
    v_perm_b32 v48, v230, v226, s60
    v_perm_b32 v49, v238, v234, s60
    v_perm_b32 v50, v246, v242, s60
    v_perm_b32 v51, v254, v250, s60
    s_nop 1
    v_mfma_f32_16x16x32_bf16 v[80:83], v[48:51], v[40:43], v[80:83]
    v_perm_b32 v52, v230, v226, s61
    v_perm_b32 v53, v238, v234, s61
    v_perm_b32 v54, v246, v242, s61
    v_perm_b32 v55, v254, v250, s61
    s_nop 1
    v_mfma_f32_16x16x32_bf16 v[84:87], v[52:55], v[40:43], v[84:87]
    v_perm_b32 v56, v231, v227, s60
    v_perm_b32 v57, v239, v235, s60
    v_perm_b32 v58, v247, v243, s60
    s_waitcnt vmcnt(7)
    s_xor_b32 s5, s5, 24576
    buffer_load_dwordx4 v[144:147], v8, s[16:19], s5 offen offset:0 nt
    v_perm_b32 v59, v255, v251, s60
    s_nop 1
    v_mfma_f32_16x16x32_bf16 v[88:91], v[56:59], v[40:43], v[88:91]
    v_perm_b32 v60, v231, v227, s61
    v_perm_b32 v61, v239, v235, s61
    v_perm_b32 v62, v247, v243, s61
    v_perm_b32 v63, v255, v251, s61
    s_nop 1
    v_mfma_f32_16x16x32_bf16 v[92:95], v[60:63], v[40:43], v[92:95]
    s_waitcnt lgkmcnt(0)
    v_mfma_f32_16x16x32_bf16 v[24:27], v[160:163], v[16:19], 0
    v_mfma_f32_16x16x32_bf16 v[24:27], v[164:167], v[20:23], v[24:27]
    v_mfma_f32_16x16x32_bf16 v[28:31], v[168:171], v[16:19], 0
    v_mfma_f32_16x16x32_bf16 v[28:31], v[172:175], v[20:23], v[28:31]
    v_mfma_f32_16x16x32_bf16 v[32:35], v[176:179], v[16:19], 0
    v_mfma_f32_16x16x32_bf16 v[32:35], v[180:183], v[20:23], v[32:35]
    v_mfma_f32_16x16x32_bf16 v[36:39], v[184:187], v[16:19], 0
    v_mfma_f32_16x16x32_bf16 v[36:39], v[188:191], v[20:23], v[36:39]
    s_nop 1
    v_add_f32_dpp v48, v25, v24 row_ror:8 row_mask:0xf bank_mask:0xf
    v_add_f32_dpp v49, v27, v26 row_ror:8 row_mask:0xf bank_mask:0xf
    v_cvt_pk_bf16_f32 v46, v48, v49
    v_lshlrev_b32 v48, 16, v46
    v_and_b32 v49, s62, v46
    v_mul_f32 v48, s59, v48
    v_mul_f32 v49, s59, v49
    v_cvt_pk_bf16_f32 v46, v48, v49
    v_lshlrev_b32 v48, 16, v46
    v_and_b32 v49, s62, v46
    v_max3_f32 v47, v44, v48, v49
    v_add_f32_dpp v50, v29, v28 row_ror:8 row_mask:0xf bank_mask:0xf
    v_add_f32_dpp v51, v31, v30 row_ror:8 row_mask:0xf bank_mask:0xf
    v_cvt_pk_bf16_f32 v46, v50, v51
    v_lshlrev_b32 v50, 16, v46
    v_and_b32 v51, s62, v46
    v_mul_f32 v50, s59, v50
    v_mul_f32 v51, s59, v51
    v_cvt_pk_bf16_f32 v46, v50, v51
    v_lshlrev_b32 v50, 16, v46
    v_and_b32 v51, s62, v46
    v_max3_f32 v47, v47, v50, v51
    v_add_f32_dpp v52, v33, v32 row_ror:8 row_mask:0xf bank_mask:0xf
    v_add_f32_dpp v53, v35, v34 row_ror:8 row_mask:0xf bank_mask:0xf
    v_cvt_pk_bf16_f32 v46, v52, v53
    v_lshlrev_b32 v52, 16, v46
    v_and_b32 v53, s62, v46
    s_waitcnt vmcnt(7)
    buffer_load_dwordx4 v[148:151], v8, s[16:19], s5 offen offset:1024 nt
    v_mul_f32 v52, s59, v52
    v_mul_f32 v53, s59, v53
    v_cvt_pk_bf16_f32 v46, v52, v53
    v_lshlrev_b32 v52, 16, v46
    v_and_b32 v53, s62, v46
    v_max3_f32 v47, v47, v52, v53
    v_add_f32_dpp v54, v37, v36 row_ror:8 row_mask:0xf bank_mask:0xf
    v_add_f32_dpp v55, v39, v38 row_ror:8 row_mask:0xf bank_mask:0xf
    v_cvt_pk_bf16_f32 v46, v54, v55
    v_lshlrev_b32 v54, 16, v46
    v_and_b32 v55, s62, v46
    v_mul_f32 v54, s59, v54
    v_mul_f32 v55, s59, v55
    v_cvt_pk_bf16_f32 v46, v54, v55
    v_lshlrev_b32 v54, 16, v46
    v_and_b32 v55, s62, v46
    v_max3_f32 v47, v47, v54, v55
    v_mov_b32 v46, v47
    s_nop 1
    v_permlane16_swap_b32 v47, v46
    v_max_f32 v47, v47, v46
    v_mov_b32 v46, v47
    s_nop 1
    v_permlane32_swap_b32 v47, v46
    v_max_f32 v47, v47, v46
    v_sub_f32 v46, v44, v47
    v_mul_f32 v46, s63, v46
    v_exp_f32 v46, v46
    v_mov_b32 v44, v47
    v_mul_f32 v47, s63, v47
    v_fma_f32 v48, v48, s63, -v47
    v_fma_f32 v49, v49, s63, -v47
    v_fma_f32 v50, v50, s63, -v47
    v_fma_f32 v51, v51, s63, -v47
    v_fma_f32 v52, v52, s63, -v47
    v_fma_f32 v53, v53, s63, -v47
    v_fma_f32 v54, v54, s63, -v47
    v_fma_f32 v55, v55, s63, -v47
    v_exp_f32 v48, v48
    v_exp_f32 v49, v49
    v_exp_f32 v50, v50
    v_exp_f32 v51, v51
    v_exp_f32 v52, v52
    v_exp_f32 v53, v53
    v_exp_f32 v54, v54
    s_waitcnt vmcnt(7)
    s_xor_b32 s5, s5, 8192
    buffer_load_dwordx4 v[152:155], v8, s[16:19], s5 offen offset:0 nt
    v_exp_f32 v55, v55
    v_fma_f32 v45, v45, v46, v48
    v_mul_f32 v64, v46, v64
    v_mul_f32 v65, v46, v65
    v_mul_f32 v66, v46, v66
    v_mul_f32 v67, v46, v67
    v_mul_f32 v68, v46, v68
    v_mul_f32 v69, v46, v69
    v_mul_f32 v70, v46, v70
    v_mul_f32 v71, v46, v71
    v_mul_f32 v72, v46, v72
    v_mul_f32 v73, v46, v73
    v_mul_f32 v74, v46, v74
    v_mul_f32 v75, v46, v75
    v_mul_f32 v76, v46, v76
    v_mul_f32 v77, v46, v77
    v_mul_f32 v78, v46, v78
    v_mul_f32 v79, v46, v79
    v_mul_f32 v80, v46, v80
    v_mul_f32 v81, v46, v81
    v_mul_f32 v82, v46, v82
    v_mul_f32 v83, v46, v83
    v_mul_f32 v84, v46, v84
    v_mul_f32 v85, v46, v85
    v_mul_f32 v86, v46, v86
    v_mul_f32 v87, v46, v87
    v_mul_f32 v88, v46, v88
    v_mul_f32 v89, v46, v89
    v_mul_f32 v90, v46, v90
    v_mul_f32 v91, v46, v91
    v_mul_f32 v92, v46, v92
    v_mul_f32 v93, v46, v93
    v_mul_f32 v94, v46, v94
    v_mul_f32 v95, v46, v95
    v_add_f32 v45, v45, v49
    v_add_f32 v45, v45, v50
    v_add_f32 v45, v45, v51
    v_add_f32 v45, v45, v52
    v_add_f32 v45, v45, v53
    v_add_f32 v45, v45, v54
    v_add_f32 v45, v45, v55
    v_cvt_pk_bf16_f32 v40, v48, v49
    v_cvt_pk_bf16_f32 v41, v50, v51
    s_waitcnt vmcnt(7)
    buffer_load_dwordx4 v[156:159], v8, s[16:19], s5 offen offset:1024 nt
    v_cvt_pk_bf16_f32 v42, v52, v53
    v_cvt_pk_bf16_f32 v43, v54, v55
    v_perm_b32 v48, v196, v192, s60
    v_perm_b32 v49, v204, v200, s60
    v_perm_b32 v50, v212, v208, s60
    v_perm_b32 v51, v220, v216, s60
    s_nop 1
    v_mfma_f32_16x16x32_bf16 v[64:67], v[48:51], v[40:43], v[64:67]
    v_perm_b32 v52, v196, v192, s61
    v_perm_b32 v53, v204, v200, s61
    v_perm_b32 v54, v212, v208, s61
    v_perm_b32 v55, v220, v216, s61
    s_nop 1
    v_mfma_f32_16x16x32_bf16 v[68:71], v[52:55], v[40:43], v[68:71]
    v_perm_b32 v56, v197, v193, s60
    v_perm_b32 v57, v205, v201, s60
    v_perm_b32 v58, v213, v209, s60
    v_perm_b32 v59, v221, v217, s60
    s_nop 1
    v_mfma_f32_16x16x32_bf16 v[72:75], v[56:59], v[40:43], v[72:75]
    v_perm_b32 v60, v197, v193, s61
    v_perm_b32 v61, v205, v201, s61
    v_perm_b32 v62, v213, v209, s61
    v_perm_b32 v63, v221, v217, s61
    s_nop 1
    v_mfma_f32_16x16x32_bf16 v[76:79], v[60:63], v[40:43], v[76:79]
    v_perm_b32 v48, v198, v194, s60
    v_perm_b32 v49, v206, v202, s60
    v_perm_b32 v50, v214, v210, s60
    v_perm_b32 v51, v222, v218, s60
    s_nop 1
    v_mfma_f32_16x16x32_bf16 v[80:83], v[48:51], v[40:43], v[80:83]
    v_perm_b32 v52, v198, v194, s61
    v_perm_b32 v53, v206, v202, s61
    v_perm_b32 v54, v214, v210, s61
    v_perm_b32 v55, v222, v218, s61
    s_nop 1
    v_mfma_f32_16x16x32_bf16 v[84:87], v[52:55], v[40:43], v[84:87]
    v_perm_b32 v56, v199, v195, s60
    v_perm_b32 v57, v207, v203, s60
    v_perm_b32 v58, v215, v211, s60
    v_perm_b32 v59, v223, v219, s60
    s_nop 1
    v_mfma_f32_16x16x32_bf16 v[88:91], v[56:59], v[40:43], v[88:91]
    v_perm_b32 v60, v199, v195, s61
    v_perm_b32 v61, v207, v203, s61
    v_perm_b32 v62, v215, v211, s61
    v_perm_b32 v63, v223, v219, s61
    s_nop 1
    v_mfma_f32_16x16x32_bf16 v[92:95], v[60:63], v[40:43], v[92:95]
L_loop:
    s_cmp_eq_u32 s24, 0
    s_cbranch_scc1 L_have0
    s_waitcnt lgkmcnt(0)
    s_cmp_ge_u32 s25, 64
    s_cbranch_scc1 L_epi0
    s_mov_b32 s27, s25
    s_and_b32 s56, s25, 3
    s_lshl_b32 s56, s56, 11
    s_lshl_b32 s21, s25, 13
    s_add_u32 s21, s21, s56
    s_add_u32 s21, s21, s26
L_have0:
    s_mov_b32 s20, s21
    s_waitcnt vmcnt(8)
    s_waitcnt vmcnt(7)
    s_add_u32 s5, s20, 0
    s_xor_b32 s5, s5, s30
    buffer_load_dwordx4 v[160:163], v7, s[12:15], s5 offen offset:0 nt
    v_mfma_f32_16x16x32_bf16 v[24:27], v[96:99], v[16:19], 0
    v_mfma_f32_16x16x32_bf16 v[24:27], v[100:103], v[20:23], v[24:27]
    v_mfma_f32_16x16x32_bf16 v[28:31], v[104:107], v[16:19], 0
    v_mfma_f32_16x16x32_bf16 v[28:31], v[108:111], v[20:23], v[28:31]
    v_mfma_f32_16x16x32_bf16 v[32:35], v[112:115], v[16:19], 0
    v_mfma_f32_16x16x32_bf16 v[32:35], v[116:119], v[20:23], v[32:35]
    v_mfma_f32_16x16x32_bf16 v[36:39], v[120:123], v[16:19], 0
    v_mfma_f32_16x16x32_bf16 v[36:39], v[124:127], v[20:23], v[36:39]
    s_nop 1
    v_add_f32_dpp v48, v25, v24 row_ror:8 row_mask:0xf bank_mask:0xf
    v_add_f32_dpp v49, v27, v26 row_ror:8 row_mask:0xf bank_mask:0xf
    v_cvt_pk_bf16_f32 v46, v48, v49
    v_lshlrev_b32 v48, 16, v46
    v_and_b32 v49, s62, v46
    v_mul_f32 v48, s59, v48
    v_mul_f32 v49, s59, v49
    v_cvt_pk_bf16_f32 v46, v48, v49
    s_waitcnt vmcnt(7)
    buffer_load_dwordx4 v[164:167], v7, s[12:15], s5 offen offset:128 nt
    v_lshlrev_b32 v48, 16, v46
    v_and_b32 v49, s62, v46
    v_max3_f32 v47, v44, v48, v49
    v_add_f32_dpp v50, v29, v28 row_ror:8 row_mask:0xf bank_mask:0xf
    v_add_f32_dpp v51, v31, v30 row_ror:8 row_mask:0xf bank_mask:0xf
    v_cvt_pk_bf16_f32 v46, v50, v51
    v_lshlrev_b32 v50, 16, v46
    v_and_b32 v51, s62, v46
    v_mul_f32 v50, s59, v50
    v_mul_f32 v51, s59, v51
    v_cvt_pk_bf16_f32 v46, v50, v51
    v_lshlrev_b32 v50, 16, v46
    v_and_b32 v51, s62, v46
    v_max3_f32 v47, v47, v50, v51
    v_add_f32_dpp v52, v33, v32 row_ror:8 row_mask:0xf bank_mask:0xf
    s_waitcnt vmcnt(7)
    s_xor_b32 s5, s5, 8192
    buffer_load_dwordx4 v[168:171], v7, s[12:15], s5 offen offset:0 nt
    v_add_f32_dpp v53, v35, v34 row_ror:8 row_mask:0xf bank_mask:0xf
    v_cvt_pk_bf16_f32 v46, v52, v53
    v_lshlrev_b32 v52, 16, v46
    v_and_b32 v53, s62, v46
    v_mul_f32 v52, s59, v52
    v_mul_f32 v53, s59, v53
    v_cvt_pk_bf16_f32 v46, v52, v53
    v_lshlrev_b32 v52, 16, v46
    v_and_b32 v53, s62, v46
    v_max3_f32 v47, v47, v52, v53
    v_add_f32_dpp v54, v37, v36 row_ror:8 row_mask:0xf bank_mask:0xf
    v_add_f32_dpp v55, v39, v38 row_ror:8 row_mask:0xf bank_mask:0xf
    v_cvt_pk_bf16_f32 v46, v54, v55
    v_lshlrev_b32 v54, 16, v46
    v_and_b32 v55, s62, v46
    v_mul_f32 v54, s59, v54
    s_waitcnt vmcnt(7)
    buffer_load_dwordx4 v[172:175], v7, s[12:15], s5 offen offset:128 nt
    v_mul_f32 v55, s59, v55
    v_cvt_pk_bf16_f32 v46, v54, v55
    v_lshlrev_b32 v54, 16, v46
    v_and_b32 v55, s62, v46
    v_max3_f32 v47, v47, v54, v55
    v_mov_b32 v46, v47
    s_nop 1
    v_permlane16_swap_b32 v47, v46
    v_max_f32 v47, v47, v46
    v_mov_b32 v46, v47
    s_nop 1
    v_permlane32_swap_b32 v47, v46
    v_max_f32 v47, v47, v46
    v_sub_f32 v46, v44, v47
    v_mul_f32 v46, s63, v46
    v_exp_f32 v46, v46
    v_mov_b32 v44, v47
    s_waitcnt vmcnt(7)
    s_xor_b32 s5, s5, 24576
    buffer_load_dwordx4 v[176:179], v7, s[12:15], s5 offen offset:0 nt
    v_mul_f32 v47, s63, v47
    v_fma_f32 v48, v48, s63, -v47
    v_fma_f32 v49, v49, s63, -v47
    v_fma_f32 v50, v50, s63, -v47
    v_fma_f32 v51, v51, s63, -v47
    v_fma_f32 v52, v52, s63, -v47
    v_fma_f32 v53, v53, s63, -v47
    v_fma_f32 v54, v54, s63, -v47
    v_fma_f32 v55, v55, s63, -v47
    v_exp_f32 v48, v48
    v_exp_f32 v49, v49
    v_exp_f32 v50, v50
    v_exp_f32 v51, v51
    v_exp_f32 v52, v52
    v_exp_f32 v53, v53
    s_waitcnt vmcnt(7)
    buffer_load_dwordx4 v[180:183], v7, s[12:15], s5 offen offset:128 nt
    v_exp_f32 v54, v54
    v_exp_f32 v55, v55
    v_fma_f32 v45, v45, v46, v48
    v_mul_f32 v64, v46, v64
    v_mul_f32 v65, v46, v65
    v_mul_f32 v66, v46, v66
    v_mul_f32 v67, v46, v67
    v_mul_f32 v68, v46, v68
    v_mul_f32 v69, v46, v69
    v_mul_f32 v70, v46, v70
    v_mul_f32 v71, v46, v71
    v_mul_f32 v72, v46, v72
    v_mul_f32 v73, v46, v73
    v_mul_f32 v74, v46, v74
    v_mul_f32 v75, v46, v75
    v_mul_f32 v76, v46, v76
    s_waitcnt vmcnt(7)
    s_xor_b32 s5, s5, 8192
    buffer_load_dwordx4 v[184:187], v7, s[12:15], s5 offen offset:0 nt
    v_mul_f32 v77, v46, v77
    v_mul_f32 v78, v46, v78
    v_mul_f32 v79, v46, v79
    v_mul_f32 v80, v46, v80
    v_mul_f32 v81, v46, v81
    v_mul_f32 v82, v46, v82
    v_mul_f32 v83, v46, v83
    v_mul_f32 v84, v46, v84
    v_mul_f32 v85, v46, v85
    v_mul_f32 v86, v46, v86
    v_mul_f32 v87, v46, v87
    v_mul_f32 v88, v46, v88
    v_mul_f32 v89, v46, v89
    v_mul_f32 v90, v46, v90
    v_mul_f32 v91, v46, v91
    s_waitcnt vmcnt(7)
    buffer_load_dwordx4 v[188:191], v7, s[12:15], s5 offen offset:128 nt
    v_mul_f32 v92, v46, v92
    v_mul_f32 v93, v46, v93
    v_mul_f32 v94, v46, v94
    v_mul_f32 v95, v46, v95
    v_add_f32 v45, v45, v49
    v_add_f32 v45, v45, v50
    v_add_f32 v45, v45, v51
    v_add_f32 v45, v45, v52
    v_add_f32 v45, v45, v53
    v_add_f32 v45, v45, v54
    v_add_f32 v45, v45, v55
    v_cvt_pk_bf16_f32 v40, v48, v49
    v_cvt_pk_bf16_f32 v41, v50, v51
    v_cvt_pk_bf16_f32 v42, v52, v53
    v_cvt_pk_bf16_f32 v43, v54, v55
    s_waitcnt vmcnt(8)
    s_waitcnt vmcnt(7)
    s_add_u32 s5, s20, 0
    s_xor_b32 s5, s5, s30
    buffer_load_dwordx4 v[192:195], v8, s[16:19], s5 offen offset:0 nt
    v_perm_b32 v48, v132, v128, s60
    v_perm_b32 v49, v140, v136, s60
    v_perm_b32 v50, v148, v144, s60
    v_perm_b32 v51, v156, v152, s60
    s_nop 1
    v_mfma_f32_16x16x32_bf16 v[64:67], v[48:51], v[40:43], v[64:67]
    s_waitcnt vmcnt(7)
    buffer_load_dwordx4 v[196:199], v8, s[16:19], s5 offen offset:1024 nt
    v_perm_b32 v52, v132, v128, s61
    v_perm_b32 v53, v140, v136, s61
    v_perm_b32 v54, v148, v144, s61
    v_perm_b32 v55, v156, v152, s61
    s_nop 1
    v_mfma_f32_16x16x32_bf16 v[68:71], v[52:55], v[40:43], v[68:71]
    s_waitcnt vmcnt(7)
    s_xor_b32 s5, s5, 8192
    buffer_load_dwordx4 v[200:203], v8, s[16:19], s5 offen offset:0 nt
    v_perm_b32 v56, v133, v129, s60
    v_perm_b32 v57, v141, v137, s60
    v_perm_b32 v58, v149, v145, s60
    v_perm_b32 v59, v157, v153, s60
    s_nop 1
    v_mfma_f32_16x16x32_bf16 v[72:75], v[56:59], v[40:43], v[72:75]
    s_waitcnt vmcnt(7)
    buffer_load_dwordx4 v[204:207], v8, s[16:19], s5 offen offset:1024 nt
    v_perm_b32 v60, v133, v129, s61
    v_perm_b32 v61, v141, v137, s61
    v_perm_b32 v62, v149, v145, s61
    v_perm_b32 v63, v157, v153, s61
    s_nop 1
    v_mfma_f32_16x16x32_bf16 v[76:79], v[60:63], v[40:43], v[76:79]
    s_waitcnt vmcnt(7)
    s_xor_b32 s5, s5, 24576
    buffer_load_dwordx4 v[208:211], v8, s[16:19], s5 offen offset:0 nt
    v_perm_b32 v48, v134, v130, s60
    v_perm_b32 v49, v142, v138, s60
    v_perm_b32 v50, v150, v146, s60
    v_perm_b32 v51, v158, v154, s60
    s_nop 1
    v_mfma_f32_16x16x32_bf16 v[80:83], v[48:51], v[40:43], v[80:83]
    s_waitcnt vmcnt(7)
    buffer_load_dwordx4 v[212:215], v8, s[16:19], s5 offen offset:1024 nt
    v_perm_b32 v52, v134, v130, s61
    v_perm_b32 v53, v142, v138, s61
    v_perm_b32 v54, v150, v146, s61
    v_perm_b32 v55, v158, v154, s61
    s_nop 1
    v_mfma_f32_16x16x32_bf16 v[84:87], v[52:55], v[40:43], v[84:87]
    s_cmp_lt_u32 s23, 7
    s_cbranch_scc0 L_dyn0
    s_mov_b64 exec, 1
    ds_add_u32 v14, v15 offset:36
    s_mov_b64 exec, -1
    s_add_u32 s21, s21, 2097152
    s_branch L_cl0
L_dyn0:
    s_cmp_lg_u32 s24, 0
    s_cbranch_scc1 L_dyn20
    s_mov_b32 s24, 1
L_dyn20:
    s_cmp_ge_u32 s25, s29
    s_mov_b32 s25, 0x10000
    s_cbranch_scc1 L_cl0
    s_mov_b32 s25, 1
    s_atomic_add s25, s[98:99], 0 glc
L_cl0:
    s_add_u32 s23, s23, 1
    s_nop 1
    s_waitcnt vmcnt(7)
    s_xor_b32 s5, s5, 8192
    buffer_load_dwordx4 v[216:219], v8, s[16:19], s5 offen offset:0 nt
    v_perm_b32 v56, v135, v131, s60
    v_perm_b32 v57, v143, v139, s60
    v_perm_b32 v58, v151, v147, s60
    v_perm_b32 v59, v159, v155, s60
    s_nop 1
    v_mfma_f32_16x16x32_bf16 v[88:91], v[56:59], v[40:43], v[88:91]
    s_waitcnt vmcnt(7)
    buffer_load_dwordx4 v[220:223], v8, s[16:19], s5 offen offset:1024 nt
    v_perm_b32 v60, v135, v131, s61
    v_perm_b32 v61, v143, v139, s61
    v_perm_b32 v62, v151, v147, s61
    v_perm_b32 v63, v159, v155, s61
    s_nop 1
    v_mfma_f32_16x16x32_bf16 v[92:95], v[60:63], v[40:43], v[92:95]
    s_cmp_eq_u32 s24, 0
    s_cbranch_scc1 L_have1
    s_waitcnt lgkmcnt(0)
    s_cmp_ge_u32 s25, 64
    s_cbranch_scc1 L_epi1
    s_mov_b32 s27, s25
    s_and_b32 s56, s25, 3
    s_lshl_b32 s56, s56, 11
    s_lshl_b32 s21, s25, 13
    s_add_u32 s21, s21, s56
    s_add_u32 s21, s21, s26
L_have1:
    s_mov_b32 s20, s21
    s_waitcnt vmcnt(8)
    s_waitcnt vmcnt(7)
    s_add_u32 s5, s20, 0
    s_xor_b32 s5, s5, s30
    buffer_load_dwordx4 v[96:99], v7, s[12:15], s5 offen offset:0 nt
    v_mfma_f32_16x16x32_bf16 v[24:27], v[160:163], v[16:19], 0
    v_mfma_f32_16x16x32_bf16 v[24:27], v[164:167], v[20:23], v[24:27]
    v_mfma_f32_16x16x32_bf16 v[28:31], v[168:171], v[16:19], 0
    v_mfma_f32_16x16x32_bf16 v[28:31], v[172:175], v[20:23], v[28:31]
    v_mfma_f32_16x16x32_bf16 v[32:35], v[176:179], v[16:19], 0
    v_mfma_f32_16x16x32_bf16 v[32:35], v[180:183], v[20:23], v[32:35]
    v_mfma_f32_16x16x32_bf16 v[36:39], v[184:187], v[16:19], 0
    v_mfma_f32_16x16x32_bf16 v[36:39], v[188:191], v[20:23], v[36:39]
    s_nop 1
    v_add_f32_dpp v48, v25, v24 row_ror:8 row_mask:0xf bank_mask:0xf
    v_add_f32_dpp v49, v27, v26 row_ror:8 row_mask:0xf bank_mask:0xf
    v_cvt_pk_bf16_f32 v46, v48, v49
    v_lshlrev_b32 v48, 16, v46
    v_and_b32 v49, s62, v46
    v_mul_f32 v48, s59, v48
    v_mul_f32 v49, s59, v49
    v_cvt_pk_bf16_f32 v46, v48, v49
    s_waitcnt vmcnt(7)
    buffer_load_dwordx4 v[100:103], v7, s[12:15], s5 offen offset:128 nt
    v_lshlrev_b32 v48, 16, v46
    v_and_b32 v49, s62, v46
    v_max3_f32 v47, v44, v48, v49
    v_add_f32_dpp v50, v29, v28 row_ror:8 row_mask:0xf bank_mask:0xf
    v_add_f32_dpp v51, v31, v30 row_ror:8 row_mask:0xf bank_mask:0xf
    v_cvt_pk_bf16_f32 v46, v50, v51
    v_lshlrev_b32 v50, 16, v46
    v_and_b32 v51, s62, v46
    v_mul_f32 v50, s59, v50
    v_mul_f32 v51, s59, v51
    v_cvt_pk_bf16_f32 v46, v50, v51
    v_lshlrev_b32 v50, 16, v46
    v_and_b32 v51, s62, v46
    v_max3_f32 v47, v47, v50, v51
    v_add_f32_dpp v52, v33, v32 row_ror:8 row_mask:0xf bank_mask:0xf
    s_waitcnt vmcnt(7)
    s_xor_b32 s5, s5, 8192
    buffer_load_dwordx4 v[104:107], v7, s[12:15], s5 offen offset:0 nt
    v_add_f32_dpp v53, v35, v34 row_ror:8 row_mask:0xf bank_mask:0xf
    v_cvt_pk_bf16_f32 v46, v52, v53
    v_lshlrev_b32 v52, 16, v46
    v_and_b32 v53, s62, v46
    v_mul_f32 v52, s59, v52
    v_mul_f32 v53, s59, v53
    v_cvt_pk_bf16_f32 v46, v52, v53
    v_lshlrev_b32 v52, 16, v46
    v_and_b32 v53, s62, v46
    v_max3_f32 v47, v47, v52, v53
    v_add_f32_dpp v54, v37, v36 row_ror:8 row_mask:0xf bank_mask:0xf
    v_add_f32_dpp v55, v39, v38 row_ror:8 row_mask:0xf bank_mask:0xf
    v_cvt_pk_bf16_f32 v46, v54, v55
    v_lshlrev_b32 v54, 16, v46
    v_and_b32 v55, s62, v46
    v_mul_f32 v54, s59, v54
    s_waitcnt vmcnt(7)
    buffer_load_dwordx4 v[108:111], v7, s[12:15], s5 offen offset:128 nt
    v_mul_f32 v55, s59, v55
    v_cvt_pk_bf16_f32 v46, v54, v55
    v_lshlrev_b32 v54, 16, v46
    v_and_b32 v55, s62, v46
    v_max3_f32 v47, v47, v54, v55
    v_mov_b32 v46, v47
    s_nop 1
    v_permlane16_swap_b32 v47, v46
    v_max_f32 v47, v47, v46
    v_mov_b32 v46, v47
    s_nop 1
    v_permlane32_swap_b32 v47, v46
    v_max_f32 v47, v47, v46
    v_sub_f32 v46, v44, v47
    v_mul_f32 v46, s63, v46
    v_exp_f32 v46, v46
    v_mov_b32 v44, v47
    s_waitcnt vmcnt(7)
    s_xor_b32 s5, s5, 24576
    buffer_load_dwordx4 v[112:115], v7, s[12:15], s5 offen offset:0 nt
    v_mul_f32 v47, s63, v47
    v_fma_f32 v48, v48, s63, -v47
    v_fma_f32 v49, v49, s63, -v47
    v_fma_f32 v50, v50, s63, -v47
    v_fma_f32 v51, v51, s63, -v47
    v_fma_f32 v52, v52, s63, -v47
    v_fma_f32 v53, v53, s63, -v47
    v_fma_f32 v54, v54, s63, -v47
    v_fma_f32 v55, v55, s63, -v47
    v_exp_f32 v48, v48
    v_exp_f32 v49, v49
    v_exp_f32 v50, v50
    v_exp_f32 v51, v51
    v_exp_f32 v52, v52
    v_exp_f32 v53, v53
    s_waitcnt vmcnt(7)
    buffer_load_dwordx4 v[116:119], v7, s[12:15], s5 offen offset:128 nt
    v_exp_f32 v54, v54
    v_exp_f32 v55, v55
    v_fma_f32 v45, v45, v46, v48
    v_mul_f32 v64, v46, v64
    v_mul_f32 v65, v46, v65
    v_mul_f32 v66, v46, v66
    v_mul_f32 v67, v46, v67
    v_mul_f32 v68, v46, v68
    v_mul_f32 v69, v46, v69
    v_mul_f32 v70, v46, v70
    v_mul_f32 v71, v46, v71
    v_mul_f32 v72, v46, v72
    v_mul_f32 v73, v46, v73
    v_mul_f32 v74, v46, v74
    v_mul_f32 v75, v46, v75
    v_mul_f32 v76, v46, v76
    s_waitcnt vmcnt(7)
    s_xor_b32 s5, s5, 8192
    buffer_load_dwordx4 v[120:123], v7, s[12:15], s5 offen offset:0 nt
    v_mul_f32 v77, v46, v77
    v_mul_f32 v78, v46, v78
    v_mul_f32 v79, v46, v79
    v_mul_f32 v80, v46, v80
    v_mul_f32 v81, v46, v81
    v_mul_f32 v82, v46, v82
    v_mul_f32 v83, v46, v83
    v_mul_f32 v84, v46, v84
    v_mul_f32 v85, v46, v85
    v_mul_f32 v86, v46, v86
    v_mul_f32 v87, v46, v87
    v_mul_f32 v88, v46, v88
    v_mul_f32 v89, v46, v89
    v_mul_f32 v90, v46, v90
    v_mul_f32 v91, v46, v91
    s_waitcnt vmcnt(7)
    buffer_load_dwordx4 v[124:127], v7, s[12:15], s5 offen offset:128 nt
    v_mul_f32 v92, v46, v92
    v_mul_f32 v93, v46, v93
    v_mul_f32 v94, v46, v94
    v_mul_f32 v95, v46, v95
    v_add_f32 v45, v45, v49
    v_add_f32 v45, v45, v50
    v_add_f32 v45, v45, v51
    v_add_f32 v45, v45, v52
    v_add_f32 v45, v45, v53
    v_add_f32 v45, v45, v54
    v_add_f32 v45, v45, v55
    v_cvt_pk_bf16_f32 v40, v48, v49
    v_cvt_pk_bf16_f32 v41, v50, v51
    v_cvt_pk_bf16_f32 v42, v52, v53
    v_cvt_pk_bf16_f32 v43, v54, v55
    s_waitcnt vmcnt(8)
    s_waitcnt vmcnt(7)
    s_add_u32 s5, s20, 0
    s_xor_b32 s5, s5, s30
    buffer_load_dwordx4 v[128:131], v8, s[16:19], s5 offen offset:0 nt
    v_perm_b32 v48, v196, v192, s60
    v_perm_b32 v49, v204, v200, s60
    v_perm_b32 v50, v212, v208, s60
    v_perm_b32 v51, v220, v216, s60
    s_nop 1
    v_mfma_f32_16x16x32_bf16 v[64:67], v[48:51], v[40:43], v[64:67]
    s_waitcnt vmcnt(7)
    buffer_load_dwordx4 v[132:135], v8, s[16:19], s5 offen offset:1024 nt
    v_perm_b32 v52, v196, v192, s61
    v_perm_b32 v53, v204, v200, s61
    v_perm_b32 v54, v212, v208, s61
    v_perm_b32 v55, v220, v216, s61
    s_nop 1
    v_mfma_f32_16x16x32_bf16 v[68:71], v[52:55], v[40:43], v[68:71]
    s_waitcnt vmcnt(7)
    s_xor_b32 s5, s5, 8192
    buffer_load_dwordx4 v[136:139], v8, s[16:19], s5 offen offset:0 nt
    v_perm_b32 v56, v197, v193, s60
    v_perm_b32 v57, v205, v201, s60
    v_perm_b32 v58, v213, v209, s60
    v_perm_b32 v59, v221, v217, s60
    s_nop 1
    v_mfma_f32_16x16x32_bf16 v[72:75], v[56:59], v[40:43], v[72:75]
    s_waitcnt vmcnt(7)
    buffer_load_dwordx4 v[140:143], v8, s[16:19], s5 offen offset:1024 nt
    v_perm_b32 v60, v197, v193, s61
    v_perm_b32 v61, v205, v201, s61
    v_perm_b32 v62, v213, v209, s61
    v_perm_b32 v63, v221, v217, s61
    s_nop 1
    v_mfma_f32_16x16x32_bf16 v[76:79], v[60:63], v[40:43], v[76:79]
    s_waitcnt vmcnt(7)
    s_xor_b32 s5, s5, 24576
    buffer_load_dwordx4 v[144:147], v8, s[16:19], s5 offen offset:0 nt
    v_perm_b32 v48, v198, v194, s60
    v_perm_b32 v49, v206, v202, s60
    v_perm_b32 v50, v214, v210, s60
    v_perm_b32 v51, v222, v218, s60
    s_nop 1
    v_mfma_f32_16x16x32_bf16 v[80:83], v[48:51], v[40:43], v[80:83]
    s_waitcnt vmcnt(7)
    buffer_load_dwordx4 v[148:151], v8, s[16:19], s5 offen offset:1024 nt
    v_perm_b32 v52, v198, v194, s61
    v_perm_b32 v53, v206, v202, s61
    v_perm_b32 v54, v214, v210, s61
    v_perm_b32 v55, v222, v218, s61
    s_nop 1
    v_mfma_f32_16x16x32_bf16 v[84:87], v[52:55], v[40:43], v[84:87]
    s_cmp_lt_u32 s23, 7
    s_cbranch_scc0 L_dyn1
    s_mov_b64 exec, 1
    ds_add_u32 v14, v15 offset:36
    s_mov_b64 exec, -1
    s_add_u32 s21, s21, 2097152
    s_branch L_cl1
L_dyn1:
    s_cmp_lg_u32 s24, 0
    s_cbranch_scc1 L_dyn21
    s_mov_b32 s24, 1
L_dyn21:
    s_cmp_ge_u32 s25, s29
    s_mov_b32 s25, 0x10000
    s_cbranch_scc1 L_cl1
    s_mov_b32 s25, 1
    s_atomic_add s25, s[98:99], 0 glc
L_cl1:
    s_add_u32 s23, s23, 1
    s_nop 1
    s_waitcnt vmcnt(7)
    s_xor_b32 s5, s5, 8192
    buffer_load_dwordx4 v[152:155], v8, s[16:19], s5 offen offset:0 nt
    v_perm_b32 v56, v199, v195, s60
    v_perm_b32 v57, v207, v203, s60
    v_perm_b32 v58, v215, v211, s60
    v_perm_b32 v59, v223, v219, s60
    s_nop 1
    v_mfma_f32_16x16x32_bf16 v[88:91], v[56:59], v[40:43], v[88:91]
    s_waitcnt vmcnt(7)
    buffer_load_dwordx4 v[156:159], v8, s[16:19], s5 offen offset:1024 nt
    v_perm_b32 v60, v199, v195, s61
    v_perm_b32 v61, v207, v203, s61
    v_perm_b32 v62, v215, v211, s61
    v_perm_b32 v63, v223, v219, s61
    s_nop 1
    v_mfma_f32_16x16x32_bf16 v[92:95], v[60:63], v[40:43], v[92:95]
    s_branch L_loop
L_epi0:
    v_mov_b32 v13, s27
    ds_max_u32 v14, v13 offset:52
    s_mov_b64 exec, 1
    ds_add_u32 v14, v15 offset:12
    s_mov_b64 exec, -1
L_epib0:
    s_setprio 3
    s_waitcnt vmcnt(8)
    v_mfma_f32_16x16x32_bf16 v[24:27], v[96:99], v[16:19], 0
    v_mfma_f32_16x16x32_bf16 v[24:27], v[100:103], v[20:23], v[24:27]
    v_mfma_f32_16x16x32_bf16 v[28:31], v[104:107], v[16:19], 0
    v_mfma_f32_16x16x32_bf16 v[28:31], v[108:111], v[20:23], v[28:31]
    v_mfma_f32_16x16x32_bf16 v[32:35], v[112:115], v[16:19], 0
    v_mfma_f32_16x16x32_bf16 v[32:35], v[116:119], v[20:23], v[32:35]
    v_mfma_f32_16x16x32_bf16 v[36:39], v[120:123], v[16:19], 0
    v_mfma_f32_16x16x32_bf16 v[36:39], v[124:127], v[20:23], v[36:39]
    s_nop 1
    v_add_f32_dpp v48, v25, v24 row_ror:8 row_mask:0xf bank_mask:0xf
    v_add_f32_dpp v49, v27, v26 row_ror:8 row_mask:0xf bank_mask:0xf
    v_cvt_pk_bf16_f32 v46, v48, v49
    v_lshlrev_b32 v48, 16, v46
    v_and_b32 v49, s62, v46
    v_mul_f32 v48, s59, v48
    v_mul_f32 v49, s59, v49
    v_cvt_pk_bf16_f32 v46, v48, v49
    v_lshlrev_b32 v48, 16, v46
    v_and_b32 v49, s62, v46
    v_max3_f32 v47, v44, v48, v49
    v_add_f32_dpp v50, v29, v28 row_ror:8 row_mask:0xf bank_mask:0xf
    v_add_f32_dpp v51, v31, v30 row_ror:8 row_mask:0xf bank_mask:0xf
    v_cvt_pk_bf16_f32 v46, v50, v51
    v_lshlrev_b32 v50, 16, v46
    v_and_b32 v51, s62, v46
    v_mul_f32 v50, s59, v50
    v_mul_f32 v51, s59, v51
    v_cvt_pk_bf16_f32 v46, v50, v51
    v_lshlrev_b32 v50, 16, v46
    v_and_b32 v51, s62, v46
    v_max3_f32 v47, v47, v50, v51
    v_add_f32_dpp v52, v33, v32 row_ror:8 row_mask:0xf bank_mask:0xf
    v_add_f32_dpp v53, v35, v34 row_ror:8 row_mask:0xf bank_mask:0xf
    v_cvt_pk_bf16_f32 v46, v52, v53
    v_lshlrev_b32 v52, 16, v46
    v_and_b32 v53, s62, v46
    v_mul_f32 v52, s59, v52
    v_mul_f32 v53, s59, v53
    v_cvt_pk_bf16_f32 v46, v52, v53
    v_lshlrev_b32 v52, 16, v46
    v_and_b32 v53, s62, v46
    v_max3_f32 v47, v47, v52, v53
    v_add_f32_dpp v54, v37, v36 row_ror:8 row_mask:0xf bank_mask:0xf
    v_add_f32_dpp v55, v39, v38 row_ror:8 row_mask:0xf bank_mask:0xf
    v_cvt_pk_bf16_f32 v46, v54, v55
    v_lshlrev_b32 v54, 16, v46
    v_and_b32 v55, s62, v46
    v_mul_f32 v54, s59, v54
    v_mul_f32 v55, s59, v55
    v_cvt_pk_bf16_f32 v46, v54, v55
    v_lshlrev_b32 v54, 16, v46
    v_and_b32 v55, s62, v46
    v_max3_f32 v47, v47, v54, v55
    v_mov_b32 v46, v47
    s_nop 1
    v_permlane16_swap_b32 v47, v46
    v_max_f32 v47, v47, v46
    v_mov_b32 v46, v47
    s_nop 1
    v_permlane32_swap_b32 v47, v46
    v_max_f32 v47, v47, v46
    v_sub_f32 v46, v44, v47
    v_mul_f32 v46, s63, v46
    v_exp_f32 v46, v46
    v_mov_b32 v44, v47
    v_mul_f32 v47, s63, v47
    v_fma_f32 v48, v48, s63, -v47
    v_fma_f32 v49, v49, s63, -v47
    v_fma_f32 v50, v50, s63, -v47
    v_fma_f32 v51, v51, s63, -v47
    v_fma_f32 v52, v52, s63, -v47
    v_fma_f32 v53, v53, s63, -v47
    v_fma_f32 v54, v54, s63, -v47
    v_fma_f32 v55, v55, s63, -v47
    v_exp_f32 v48, v48
    v_exp_f32 v49, v49
    v_exp_f32 v50, v50
    v_exp_f32 v51, v51
    v_exp_f32 v52, v52
    v_exp_f32 v53, v53
    v_exp_f32 v54, v54
    v_exp_f32 v55, v55
    v_fma_f32 v45, v45, v46, v48
    v_mul_f32 v64, v46, v64
    v_mul_f32 v65, v46, v65
    v_mul_f32 v66, v46, v66
    v_mul_f32 v67, v46, v67
    v_mul_f32 v68, v46, v68
    v_mul_f32 v69, v46, v69
    v_mul_f32 v70, v46, v70
    v_mul_f32 v71, v46, v71
    v_mul_f32 v72, v46, v72
    v_mul_f32 v73, v46, v73
    v_mul_f32 v74, v46, v74
    v_mul_f32 v75, v46, v75
    v_mul_f32 v76, v46, v76
    v_mul_f32 v77, v46, v77
    v_mul_f32 v78, v46, v78
    v_mul_f32 v79, v46, v79
    v_mul_f32 v80, v46, v80
    v_mul_f32 v81, v46, v81
    v_mul_f32 v82, v46, v82
    v_mul_f32 v83, v46, v83
    v_mul_f32 v84, v46, v84
    v_mul_f32 v85, v46, v85
    v_mul_f32 v86, v46, v86
    v_mul_f32 v87, v46, v87
    v_mul_f32 v88, v46, v88
    v_mul_f32 v89, v46, v89
    v_mul_f32 v90, v46, v90
    v_mul_f32 v91, v46, v91
    v_mul_f32 v92, v46, v92
    v_mul_f32 v93, v46, v93
    v_mul_f32 v94, v46, v94
    v_mul_f32 v95, v46, v95
    v_add_f32 v45, v45, v49
    v_add_f32 v45, v45, v50
    v_add_f32 v45, v45, v51
    v_add_f32 v45, v45, v52
    v_add_f32 v45, v45, v53
    v_add_f32 v45, v45, v54
    v_add_f32 v45, v45, v55
    v_cvt_pk_bf16_f32 v40, v48, v49
    v_cvt_pk_bf16_f32 v41, v50, v51
    v_cvt_pk_bf16_f32 v42, v52, v53
    v_cvt_pk_bf16_f32 v43, v54, v55
    v_mov_b32 v46, v45
    s_nop 1
    v_permlane16_swap_b32 v45, v46
    v_add_f32 v45, v45, v46
    v_mov_b32 v46, v45
    s_nop 1
    v_permlane32_swap_b32 v45, v46
    v_add_f32 v45, v45, v46
    s_mov_b64 exec, 0xff
    ds_write_b64 v12, v[44:45] offset:6144
    s_mov_b64 exec, 1
    ds_add_u32 v14, v15 offset:60
    s_mov_b64 exec, -1
    s_mov_b32 s58, 4000000
L_sp2:
    ds_read_b32 v47, v14 offset:60
    ds_read_b128 v[224:227], v5 offset:6144
    ds_read_b128 v[228:231], v5 offset:6160
    ds_read_b32 v13, v14 offset:52
    s_sub_u32 s58, s58, 1
    s_cbranch_scc1 L_end
    s_waitcnt lgkmcnt(0)
    v_readfirstlane_b32 s56, v47
    s_nop 0
    s_cmp_eq_u32 s56, 4
    s_cbranch_scc0 L_sp2
    v_max3_f32 v232, v224, v226, v228
    v_max_f32 v232, v232, v230
    v_mul_f32 v232, s63, v232
    v_fma_f32 v224, v224, s63, -v232
    v_fma_f32 v226, v226, s63, -v232
    v_fma_f32 v228, v228, s63, -v232
    v_fma_f32 v230, v230, s63, -v232
    v_exp_f32 v224, v224
    v_exp_f32 v226, v226
    v_exp_f32 v228, v228
    v_exp_f32 v230, v230
    v_mul_f32 v233, v224, v225
    v_fmac_f32 v233, v226, v227
    v_fmac_f32 v233, v228, v229
    v_fmac_f32 v233, v230, v231
    v_rcp_f32 v234, v233
    v_log_f32 v233, v233
    v_mul_f32 v224, v234, v224
    v_mul_f32 v226, v234, v226
    v_mul_f32 v228, v234, v228
    v_mul_f32 v230, v234, v230
    v_add_f32 v233, v233, v232
    v_perm_b32 v237, v233, v2, s91
    v_perm_b32 v239, v233, v2, s60
    s_waitcnt vmcnt(6)
    v_perm_b32 v96, v132, v128, s60
    v_perm_b32 v100, v132, v128, s61
    v_perm_b32 v104, v133, v129, s60
    v_perm_b32 v108, v133, v129, s61
    v_perm_b32 v112, v134, v130, s60
    v_perm_b32 v116, v134, v130, s61
    v_perm_b32 v120, v135, v131, s60
    v_perm_b32 v124, v135, v131, s61
    s_waitcnt vmcnt(4)
    v_perm_b32 v97, v140, v136, s60
    v_perm_b32 v101, v140, v136, s61
    v_perm_b32 v105, v141, v137, s60
    v_perm_b32 v109, v141, v137, s61
    v_perm_b32 v113, v142, v138, s60
    v_perm_b32 v117, v142, v138, s61
    v_perm_b32 v121, v143, v139, s60
    v_perm_b32 v125, v143, v139, s61
    s_waitcnt vmcnt(2)
    v_perm_b32 v98, v148, v144, s60
    v_perm_b32 v102, v148, v144, s61
    v_perm_b32 v106, v149, v145, s60
    v_perm_b32 v110, v149, v145, s61
    v_perm_b32 v114, v150, v146, s60
    v_perm_b32 v118, v150, v146, s61
    v_perm_b32 v122, v151, v147, s60
    v_perm_b32 v126, v151, v147, s61
    s_waitcnt vmcnt(0)
    v_perm_b32 v99, v156, v152, s60
    v_perm_b32 v103, v156, v152, s61
    v_perm_b32 v107, v157, v153, s60
    v_mfma_f32_16x16x32_bf16 v[64:67], v[96:99], v[40:43], v[64:67]
    v_perm_b32 v111, v157, v153, s61
    v_mfma_f32_16x16x32_bf16 v[68:71], v[100:103], v[40:43], v[68:71]
    v_perm_b32 v115, v158, v154, s60
    v_mfma_f32_16x16x32_bf16 v[72:75], v[104:107], v[40:43], v[72:75]
    v_perm_b32 v119, v158, v154, s61
    v_mfma_f32_16x16x32_bf16 v[76:79], v[108:111], v[40:43], v[76:79]
    v_perm_b32 v123, v159, v155, s60
    v_mfma_f32_16x16x32_bf16 v[80:83], v[112:115], v[40:43], v[80:83]
    v_perm_b32 v127, v159, v155, s61
    v_mfma_f32_16x16x32_bf16 v[84:87], v[116:119], v[40:43], v[84:87]
    v_mfma_f32_16x16x32_bf16 v[88:91], v[120:123], v[40:43], v[88:91]
    v_mfma_f32_16x16x32_bf16 v[92:95], v[124:127], v[40:43], v[92:95]
    s_mov_b32 exec_lo, 0x00ff00ff
    s_mov_b32 exec_hi, 0x00ff00ff
    ds_write_b128 v11, v[64:67] offset:8192
    ds_write_b128 v11, v[68:71] offset:8208
    ds_write_b128 v11, v[72:75] offset:8224
    ds_write_b128 v11, v[76:79] offset:8240
    ds_write_b128 v11, v[80:83] offset:8256
    ds_write_b128 v11, v[84:87] offset:8272
    ds_write_b128 v11, v[88:91] offset:8288
    ds_write_b128 v11, v[92:95] offset:8304
    s_branch L_att_done
L_epi1:
    v_mov_b32 v13, s27
    ds_max_u32 v14, v13 offset:52
    s_mov_b64 exec, 1
    ds_add_u32 v14, v15 offset:12
    s_mov_b64 exec, -1
L_epib1:
    s_setprio 3
    s_waitcnt vmcnt(8)
    v_mfma_f32_16x16x32_bf16 v[24:27], v[160:163], v[16:19], 0
    v_mfma_f32_16x16x32_bf16 v[24:27], v[164:167], v[20:23], v[24:27]
    v_mfma_f32_16x16x32_bf16 v[28:31], v[168:171], v[16:19], 0
    v_mfma_f32_16x16x32_bf16 v[28:31], v[172:175], v[20:23], v[28:31]
    v_mfma_f32_16x16x32_bf16 v[32:35], v[176:179], v[16:19], 0
    v_mfma_f32_16x16x32_bf16 v[32:35], v[180:183], v[20:23], v[32:35]
    v_mfma_f32_16x16x32_bf16 v[36:39], v[184:187], v[16:19], 0
    v_mfma_f32_16x16x32_bf16 v[36:39], v[188:191], v[20:23], v[36:39]
    s_nop 1
    v_add_f32_dpp v48, v25, v24 row_ror:8 row_mask:0xf bank_mask:0xf
    v_add_f32_dpp v49, v27, v26 row_ror:8 row_mask:0xf bank_mask:0xf
    v_cvt_pk_bf16_f32 v46, v48, v49
    v_lshlrev_b32 v48, 16, v46
    v_and_b32 v49, s62, v46
    v_mul_f32 v48, s59, v48
    v_mul_f32 v49, s59, v49
    v_cvt_pk_bf16_f32 v46, v48, v49
    v_lshlrev_b32 v48, 16, v46
    v_and_b32 v49, s62, v46
    v_max3_f32 v47, v44, v48, v49
    v_add_f32_dpp v50, v29, v28 row_ror:8 row_mask:0xf bank_mask:0xf
    v_add_f32_dpp v51, v31, v30 row_ror:8 row_mask:0xf bank_mask:0xf
    v_cvt_pk_bf16_f32 v46, v50, v51
    v_lshlrev_b32 v50, 16, v46
    v_and_b32 v51, s62, v46
    v_mul_f32 v50, s59, v50
    v_mul_f32 v51, s59, v51
    v_cvt_pk_bf16_f32 v46, v50, v51
    v_lshlrev_b32 v50, 16, v46
    v_and_b32 v51, s62, v46
    v_max3_f32 v47, v47, v50, v51
    v_add_f32_dpp v52, v33, v32 row_ror:8 row_mask:0xf bank_mask:0xf
    v_add_f32_dpp v53, v35, v34 row_ror:8 row_mask:0xf bank_mask:0xf
    v_cvt_pk_bf16_f32 v46, v52, v53
    v_lshlrev_b32 v52, 16, v46
    v_and_b32 v53, s62, v46
    v_mul_f32 v52, s59, v52
    v_mul_f32 v53, s59, v53
    v_cvt_pk_bf16_f32 v46, v52, v53
    v_lshlrev_b32 v52, 16, v46
    v_and_b32 v53, s62, v46
    v_max3_f32 v47, v47, v52, v53
    v_add_f32_dpp v54, v37, v36 row_ror:8 row_mask:0xf bank_mask:0xf
    v_add_f32_dpp v55, v39, v38 row_ror:8 row_mask:0xf bank_mask:0xf
    v_cvt_pk_bf16_f32 v46, v54, v55
    v_lshlrev_b32 v54, 16, v46
    v_and_b32 v55, s62, v46
    v_mul_f32 v54, s59, v54
    v_mul_f32 v55, s59, v55
    v_cvt_pk_bf16_f32 v46, v54, v55
    v_lshlrev_b32 v54, 16, v46
    v_and_b32 v55, s62, v46
    v_max3_f32 v47, v47, v54, v55
    v_mov_b32 v46, v47
    s_nop 1
    v_permlane16_swap_b32 v47, v46
    v_max_f32 v47, v47, v46
    v_mov_b32 v46, v47
    s_nop 1
    v_permlane32_swap_b32 v47, v46
    v_max_f32 v47, v47, v46
    v_sub_f32 v46, v44, v47
    v_mul_f32 v46, s63, v46
    v_exp_f32 v46, v46
    v_mov_b32 v44, v47
    v_mul_f32 v47, s63, v47
    v_fma_f32 v48, v48, s63, -v47
    v_fma_f32 v49, v49, s63, -v47
    v_fma_f32 v50, v50, s63, -v47
    v_fma_f32 v51, v51, s63, -v47
    v_fma_f32 v52, v52, s63, -v47
    v_fma_f32 v53, v53, s63, -v47
    v_fma_f32 v54, v54, s63, -v47
    v_fma_f32 v55, v55, s63, -v47
    v_exp_f32 v48, v48
    v_exp_f32 v49, v49
    v_exp_f32 v50, v50
    v_exp_f32 v51, v51
    v_exp_f32 v52, v52
    v_exp_f32 v53, v53
    v_exp_f32 v54, v54
    v_exp_f32 v55, v55
    v_fma_f32 v45, v45, v46, v48
    v_mul_f32 v64, v46, v64
    v_mul_f32 v65, v46, v65
    v_mul_f32 v66, v46, v66
    v_mul_f32 v67, v46, v67
    v_mul_f32 v68, v46, v68
    v_mul_f32 v69, v46, v69
    v_mul_f32 v70, v46, v70
    v_mul_f32 v71, v46, v71
    v_mul_f32 v72, v46, v72
    v_mul_f32 v73, v46, v73
    v_mul_f32 v74, v46, v74
    v_mul_f32 v75, v46, v75
    v_mul_f32 v76, v46, v76
    v_mul_f32 v77, v46, v77
    v_mul_f32 v78, v46, v78
    v_mul_f32 v79, v46, v79
    v_mul_f32 v80, v46, v80
    v_mul_f32 v81, v46, v81
    v_mul_f32 v82, v46, v82
    v_mul_f32 v83, v46, v83
    v_mul_f32 v84, v46, v84
    v_mul_f32 v85, v46, v85
    v_mul_f32 v86, v46, v86
    v_mul_f32 v87, v46, v87
    v_mul_f32 v88, v46, v88
    v_mul_f32 v89, v46, v89
    v_mul_f32 v90, v46, v90
    v_mul_f32 v91, v46, v91
    v_mul_f32 v92, v46, v92
    v_mul_f32 v93, v46, v93
    v_mul_f32 v94, v46, v94
    v_mul_f32 v95, v46, v95
    v_add_f32 v45, v45, v49
    v_add_f32 v45, v45, v50
    v_add_f32 v45, v45, v51
    v_add_f32 v45, v45, v52
    v_add_f32 v45, v45, v53
    v_add_f32 v45, v45, v54
    v_add_f32 v45, v45, v55
    v_cvt_pk_bf16_f32 v40, v48, v49
    v_cvt_pk_bf16_f32 v41, v50, v51
    v_cvt_pk_bf16_f32 v42, v52, v53
    v_cvt_pk_bf16_f32 v43, v54, v55
    v_mov_b32 v46, v45
    s_nop 1
    v_permlane16_swap_b32 v45, v46
    v_add_f32 v45, v45, v46
    v_mov_b32 v46, v45
    s_nop 1
    v_permlane32_swap_b32 v45, v46
    v_add_f32 v45, v45, v46
    s_mov_b64 exec, 0xff
    ds_write_b64 v12, v[44:45] offset:6144
    s_mov_b64 exec, 1
    ds_add_u32 v14, v15 offset:60
    s_mov_b64 exec, -1
    s_mov_b32 s58, 4000000
L_sp3:
    ds_read_b32 v47, v14 offset:60
    ds_read_b128 v[224:227], v5 offset:6144
    ds_read_b128 v[228:231], v5 offset:6160
    ds_read_b32 v13, v14 offset:52
    s_sub_u32 s58, s58, 1
    s_cbranch_scc1 L_end
    s_waitcnt lgkmcnt(0)
    v_readfirstlane_b32 s56, v47
    s_nop 0
    s_cmp_eq_u32 s56, 4
    s_cbranch_scc0 L_sp3
    v_max3_f32 v232, v224, v226, v228
    v_max_f32 v232, v232, v230
    v_mul_f32 v232, s63, v232
    v_fma_f32 v224, v224, s63, -v232
    v_fma_f32 v226, v226, s63, -v232
    v_fma_f32 v228, v228, s63, -v232
    v_fma_f32 v230, v230, s63, -v232
    v_exp_f32 v224, v224
    v_exp_f32 v226, v226
    v_exp_f32 v228, v228
    v_exp_f32 v230, v230
    v_mul_f32 v233, v224, v225
    v_fmac_f32 v233, v226, v227
    v_fmac_f32 v233, v228, v229
    v_fmac_f32 v233, v230, v231
    v_rcp_f32 v234, v233
    v_log_f32 v233, v233
    v_mul_f32 v224, v234, v224
    v_mul_f32 v226, v234, v226
    v_mul_f32 v228, v234, v228
    v_mul_f32 v230, v234, v230
    v_add_f32 v233, v233, v232
    v_perm_b32 v237, v233, v2, s91
    v_perm_b32 v239, v233, v2, s60
    s_waitcnt vmcnt(6)
    v_perm_b32 v160, v196, v192, s60
    v_perm_b32 v164, v196, v192, s61
    v_perm_b32 v168, v197, v193, s60
    v_perm_b32 v172, v197, v193, s61
    v_perm_b32 v176, v198, v194, s60
    v_perm_b32 v180, v198, v194, s61
    v_perm_b32 v184, v199, v195, s60
    v_perm_b32 v188, v199, v195, s61
    s_waitcnt vmcnt(4)
    v_perm_b32 v161, v204, v200, s60
    v_perm_b32 v165, v204, v200, s61
    v_perm_b32 v169, v205, v201, s60
    v_perm_b32 v173, v205, v201, s61
    v_perm_b32 v177, v206, v202, s60
    v_perm_b32 v181, v206, v202, s61
    v_perm_b32 v185, v207, v203, s60
    v_perm_b32 v189, v207, v203, s61
    s_waitcnt vmcnt(2)
    v_perm_b32 v162, v212, v208, s60
    v_perm_b32 v166, v212, v208, s61
    v_perm_b32 v170, v213, v209, s60
    v_perm_b32 v174, v213, v209, s61
    v_perm_b32 v178, v214, v210, s60
    v_perm_b32 v182, v214, v210, s61
    v_perm_b32 v186, v215, v211, s60
    v_perm_b32 v190, v215, v211, s61
    s_waitcnt vmcnt(0)
    v_perm_b32 v163, v220, v216, s60
    v_perm_b32 v167, v220, v216, s61
    v_perm_b32 v171, v221, v217, s60
    v_mfma_f32_16x16x32_bf16 v[64:67], v[160:163], v[40:43], v[64:67]
    v_perm_b32 v175, v221, v217, s61
    v_mfma_f32_16x16x32_bf16 v[68:71], v[164:167], v[40:43], v[68:71]
    v_perm_b32 v179, v222, v218, s60
    v_mfma_f32_16x16x32_bf16 v[72:75], v[168:171], v[40:43], v[72:75]
    v_perm_b32 v183, v222, v218, s61
    v_mfma_f32_16x16x32_bf16 v[76:79], v[172:175], v[40:43], v[76:79]
    v_perm_b32 v187, v223, v219, s60
    v_mfma_f32_16x16x32_bf16 v[80:83], v[176:179], v[40:43], v[80:83]
    v_perm_b32 v191, v223, v219, s61
    v_mfma_f32_16x16x32_bf16 v[84:87], v[180:183], v[40:43], v[84:87]
    v_mfma_f32_16x16x32_bf16 v[88:91], v[184:187], v[40:43], v[88:91]
    v_mfma_f32_16x16x32_bf16 v[92:95], v[188:191], v[40:43], v[92:95]
    s_mov_b32 exec_lo, 0x00ff00ff
    s_mov_b32 exec_hi, 0x00ff00ff
    ds_write_b128 v11, v[64:67] offset:8192
    ds_write_b128 v11, v[68:71] offset:8208
    ds_write_b128 v11, v[72:75] offset:8224
    ds_write_b128 v11, v[76:79] offset:8240
    ds_write_b128 v11, v[80:83] offset:8256
    ds_write_b128 v11, v[84:87] offset:8272
    ds_write_b128 v11, v[88:91] offset:8288
    ds_write_b128 v11, v[92:95] offset:8304
L_att_done:
    s_mov_b64 exec, 1
    ds_add_u32 v14, v15 offset:16
    s_mov_b64 exec, -1
    s_mov_b32 s58, 4000000
L_sp4:
    ds_read_b32 v47, v14 offset:16
    ds_read_b128 v[48:51], v6 offset:8192
    ds_read_b128 v[52:55], v6 offset:12416
    ds_read_b128 v[56:59], v6 offset:16640
    ds_read_b128 v[60:63], v6 offset:20864
    s_sub_u32 s58, s58, 1
    s_cbranch_scc1 L_end
    s_waitcnt lgkmcnt(0)
    v_readfirstlane_b32 s56, v47
    s_nop 0
    s_cmp_eq_u32 s56, 4
    s_cbranch_scc0 L_sp4
    v_mul_f32 v48, v224, v48
    v_mul_f32 v56, v228, v56
    v_mul_f32 v49, v224, v49
    v_mul_f32 v57, v228, v57
    v_mul_f32 v50, v224, v50
    v_mul_f32 v58, v228, v58
    v_mul_f32 v51, v224, v51
    v_mul_f32 v59, v228, v59
    v_fmac_f32 v48, v226, v52
    v_fmac_f32 v56, v230, v60
    v_fmac_f32 v49, v226, v53
    v_fmac_f32 v57, v230, v61
    v_fmac_f32 v50, v226, v54
    v_fmac_f32 v58, v230, v62
    v_fmac_f32 v51, v226, v55
    v_fmac_f32 v59, v230, v63
    v_add_f32 v48, v48, v56
    v_add_f32 v49, v49, v57
    v_add_f32 v50, v50, v58
    v_add_f32 v51, v51, v59
    v_cvt_pk_bf16_f32 v236, v48, v49
    v_cvt_pk_bf16_f32 v238, v50, v51
    buffer_store_dwordx4 v[236:239], v4, s[44:47], s92 offen sc1
    s_mov_b64 exec, 1
    ds_add_u32 v14, v15 offset:40
    s_mov_b64 exec, -1
    v_readfirstlane_b32 s56, v13
    s_nop 0
    s_cmp_lt_u32 s56, 48
    s_cbranch_scc1 L_o_notlate
    s_mov_b32 s58, 1000000
    s_waitcnt vmcnt(0)
    buffer_load_dwordx4 v[32:35], v8, s[44:47], s93 offen sc1
    buffer_load_dwordx4 v[48:51], v8, s[44:47], s93 offen offset:1024 sc1
    s_mov_b64 exec, 1
    ds_add_u32 v14, v15 offset:56
    s_mov_b64 exec, -1
    s_branch L_o_chk
L_o_notlate:
    s_mov_b64 exec, 1
    ds_add_u32 v14, v15 offset:56
    s_mov_b64 exec, -1
    s_nop 1
    s_mov_b32 s58, 4000000
L_sp5:
    ds_read_b32 v47, v14 offset:32
    s_sub_u32 s58, s58, 1
    s_cbranch_scc1 L_end
    s_waitcnt lgkmcnt(0)
    v_readfirstlane_b32 s56, v47
    s_nop 0
    s_cmp_ge_u32 s56, 4
    s_cbranch_scc1 L_sd5
    s_sleep 1
    s_branch L_sp5
L_sd5:
    s_mov_b32 s58, 1000000
    s_waitcnt vmcnt(0)
    s_mov_b32 s92, 1
    s_mov_b32 s97, 1
L_o_poll:
    s_cmp_eq_u32 s92, 0
    s_cbranch_scc1 L_o_s0
    buffer_load_dwordx4 v[32:35], v8, s[44:47], s93 offen offset:0 sc1
L_o_s0:
    s_cmp_eq_u32 s97, 0
    s_cbranch_scc1 L_o_s1
    buffer_load_dwordx4 v[48:51], v8, s[44:47], s93 offen offset:1024 sc1
L_o_s1:
L_o_chk:
    s_sub_u32 s58, s58, 1
    s_cbranch_scc1 L_end
    s_waitcnt vmcnt(0)
    v_cmp_ne_u16 vcc, s89, v33
    v_cmp_ne_u16 s[56:57], s89, v35
    s_nop 0
    s_or_b64 vcc, vcc, s[56:57]
    s_bcnt1_i32_b64 s92, vcc
    v_cmp_ne_u16 vcc, s89, v49
    v_cmp_ne_u16 s[56:57], s89, v51
    s_nop 0
    s_or_b64 vcc, vcc, s[56:57]
    s_bcnt1_i32_b64 s97, vcc
    s_add_u32 s96, s92, s97
    s_cmp_eq_u32 s96, 0
    s_cbranch_scc1 L_o_got
    s_sleep 1
    s_cmp_lt_u32 s96, 24
    s_cbranch_scc1 L_o_poll
    s_sleep 8
    s_branch L_o_poll
L_o_got:
    v_perm_b32 v40, v33, v35, s61
    v_perm_b32 v41, v49, v51, s61
    v_max_f32 v44, v40, v41
    v_and_b32 v33, s62, v32
    v_lshlrev_b32 v32, 16, v32
    v_max_f32_dpp v44, v44, v44 row_ror:8 row_mask:0xf bank_mask:0xf
    v_and_b32 v35, s62, v34
    v_lshlrev_b32 v34, 16, v34
    v_mov_b32 v45, v44
    v_and_b32 v49, s62, v48
    v_lshlrev_b32 v48, 16, v48
    v_permlane16_swap_b32 v44, v45
    v_max_f32 v44, v44, v45
    v_mov_b32 v45, v44
    v_and_b32 v51, s62, v50
    v_lshlrev_b32 v50, 16, v50
    v_permlane32_swap_b32 v44, v45
    v_max_f32 v44, v44, v45
    v_sub_f32 v40, v40, v44
    v_sub_f32 v41, v41, v44
    v_exp_f32 v40, v40
    v_exp_f32 v41, v41
    v_mul_f32 v32, v40, v32
    v_mul_f32 v33, v40, v33
    v_mul_f32 v34, v40, v34
    v_mul_f32 v35, v40, v35
    v_add_f32 v36, v40, v41
    v_fmac_f32 v32, v41, v48
    v_fmac_f32 v33, v41, v49
    v_fmac_f32 v34, v41, v50
    v_fmac_f32 v35, v41, v51
    v_mov_b32 v37, v36
    v_permlane16_swap_b32 v32, v33
    v_permlane16_swap_b32 v34, v35
    v_permlane16_swap_b32 v36, v37
    v_add_f32 v32, v32, v33
    v_add_f32 v34, v34, v35
    v_add_f32 v36, v36, v37
    v_mov_b32 v37, v36
    v_permlane32_swap_b32 v32, v34
    s_nop 0
    v_permlane32_swap_b32 v36, v37
    v_add_f32 v32, v32, v34
    v_add_f32 v36, v36, v37
    s_nop 0
    v_add_f32_dpp v32, v32, v32 row_ror:8 row_mask:0xf bank_mask:0xf
    v_add_f32_dpp v36, v36, v36 row_ror:8 row_mask:0xf bank_mask:0xf
    s_mov_b32 exec_lo, 0x00ff00ff
    s_mov_b32 exec_hi, 0x00ff00ff
    ds_write_b32 v3, v32 offset:6912
    s_mov_b64 exec, 1
    ds_write_b32 v3, v36 offset:7424
    ds_write_b32 v3, v44 offset:7440
    ds_add_rtn_u32 v47, v14, v15 offset:20
    s_mov_b32 exec_lo, -1
    ds_read_b128 v[40:43], v14 offset:7440
    ds_read_b128 v[36:39], v14 offset:7424
    ds_read_b128 v[32:35], v8 offset:6912
    v_lshlrev_b32 v3, 1, v1
    s_waitcnt lgkmcnt(2)
    v_readfirstlane_b32 s56, v47
    s_nop 0
    s_cmp_lg_u32 s56, 3
    s_cbranch_scc1 L_a_done
    v_max3_f32 v44, v40, v41, v42
    v_max_f32 v44, v44, v43
    v_sub_f32 v40, v40, v44
    v_sub_f32 v41, v41, v44
    v_sub_f32 v42, v42, v44
    v_sub_f32 v43, v43, v44
    v_exp_f32 v40, v40
    v_exp_f32 v41, v41
    v_exp_f32 v42, v42
    v_exp_f32 v43, v43
    s_waitcnt lgkmcnt(0)
    v_mul_f32 v36, v36, v40
    v_mul_f32 v32, v32, v40
    v_fmac_f32 v36, v37, v41
    v_fmac_f32 v32, v33, v41
    v_fmac_f32 v36, v38, v42
    v_fmac_f32 v32, v34, v42
    v_fmac_f32 v36, v39, v43
    v_fmac_f32 v32, v35, v43
    v_rcp_f32 v36, v36
    s_nop 0
    v_mul_f32 v32, v32, v36
    v_cvt_pk_bf16_f32 v32, v32, v32
    ds_write_b16 v3, v32 offset:128
    s_mov_b64 exec, 1
    ds_write_b32 v14, v15 offset:28
    s_mov_b64 exec, -1
L_a_done:
    s_mov_b64 exec, -1
    s_branch L_final
L_helper:
    s_waitcnt vmcnt(8)
    v_lshlrev_b32 v48, 16, v32
    v_and_b32 v49, s62, v32
    v_lshlrev_b32 v50, 16, v33
    v_and_b32 v51, s62, v33
    v_lshlrev_b32 v52, 16, v34
    v_and_b32 v53, s62, v34
    v_lshlrev_b32 v54, 16, v35
    v_and_b32 v55, s62, v35
    v_lshlrev_b32 v56, 16, v36
    v_and_b32 v57, s62, v36
    v_lshlrev_b32 v58, 16, v37
    v_and_b32 v59, s62, v37
    v_lshlrev_b32 v60, 16, v38
    v_and_b32 v61, s62, v38
    v_lshlrev_b32 v62, 16, v39
    v_and_b32 v63, s62, v39
    v_add_f32 v32, v48, v49
    v_add_f32 v33, v50, v51
    v_add_f32 v32, v32, v52
    v_add_f32 v33, v33, v53
    v_add_f32 v32, v32, v54
    v_add_f32 v33, v33, v55
    v_add_f32 v32, v32, v56
    v_add_f32 v33, v33, v57
    v_add_f32 v32, v32, v58
    v_add_f32 v33, v33, v59
    v_add_f32 v32, v32, v60
    v_add_f32 v33, v33, v61
    v_add_f32 v32, v32, v62
    v_add_f32 v33, v33, v63
    v_add_f32 v32, v32, v33
    s_nop 1
    v_add_f32_dpp v32, v32, v32 quad_perm:[1,0,3,2] row_mask:0xf bank_mask:0xf
    s_nop 1
    v_add_f32_dpp v32, v32, v32 quad_perm:[2,3,0,1] row_mask:0xf bank_mask:0xf
    s_nop 1
    v_add_f32_dpp v32, v32, v32 row_half_mirror row_mask:0xf bank_mask:0xf
    s_nop 1
    v_add_f32_dpp v32, v32, v32 row_mirror row_mask:0xf bank_mask:0xf
    v_mov_b32 v33, v32
    s_nop 1
    v_permlane16_swap_b32 v32, v33
    v_add_f32 v32, v32, v33
    v_mov_b32 v33, v32
    s_nop 1
    v_permlane32_swap_b32 v32, v33
    v_add_f32 v32, v32, v33
    v_mul_f32 v32, 0x3a800000, v32
    v_sub_f32 v48, v48, v32
    v_sub_f32 v49, v49, v32
    v_sub_f32 v50, v50, v32
    v_sub_f32 v51, v51, v32
    v_sub_f32 v52, v52, v32
    v_sub_f32 v53, v53, v32
    v_sub_f32 v54, v54, v32
    v_sub_f32 v55, v55, v32
    v_sub_f32 v56, v56, v32
    v_sub_f32 v57, v57, v32
    v_sub_f32 v58, v58, v32
    v_sub_f32 v59, v59, v32
    v_sub_f32 v60, v60, v32
    v_sub_f32 v61, v61, v32
    v_sub_f32 v62, v62, v32
    v_sub_f32 v63, v63, v32
    v_mul_f32 v34, v48, v48
    v_mul_f32 v35, v49, v49
    v_fmac_f32 v34, v50, v50
    v_fmac_f32 v35, v51, v51
    v_fmac_f32 v34, v52, v52
    v_fmac_f32 v35, v53, v53
    v_fmac_f32 v34, v54, v54
    v_fmac_f32 v35, v55, v55
    v_fmac_f32 v34, v56, v56
    v_fmac_f32 v35, v57, v57
    v_fmac_f32 v34, v58, v58
    v_fmac_f32 v35, v59, v59
    v_fmac_f32 v34, v60, v60
    v_fmac_f32 v35, v61, v61
    v_fmac_f32 v34, v62, v62
    v_fmac_f32 v35, v63, v63
    v_add_f32 v34, v34, v35
    s_nop 1
    v_add_f32_dpp v34, v34, v34 quad_perm:[1,0,3,2] row_mask:0xf bank_mask:0xf
    s_nop 1
    v_add_f32_dpp v34, v34, v34 quad_perm:[2,3,0,1] row_mask:0xf bank_mask:0xf
    s_nop 1
    v_add_f32_dpp v34, v34, v34 row_half_mirror row_mask:0xf bank_mask:0xf
    s_nop 1
    v_add_f32_dpp v34, v34, v34 row_mirror row_mask:0xf bank_mask:0xf
    v_mov_b32 v33, v34
    s_nop 1
    v_permlane16_swap_b32 v34, v33
    v_add_f32 v34, v34, v33
    v_mov_b32 v33, v34
    s_nop 1
    v_permlane32_swap_b32 v34, v33
    v_add_f32 v34, v34, v33
    v_mul_f32 v34, 0x3a800000, v34
    v_cvt_pk_bf16_f32 v32, v32, v32
    v_lshlrev_b32 v32, 16, v32
    v_cvt_pk_bf16_f32 v34, v34, v34
    v_lshlrev_b32 v34, 16, v34
    v_add_f32 v34, 0x3727c5ac, v34
    v_cvt_pk_bf16_f32 v34, v34, v34
    v_lshlrev_b32 v34, 16, v34
    v_sqrt_f32 v34, v34
    s_nop 0
    v_cvt_pk_bf16_f32 v34, v34, v34
    v_lshlrev_b32 v34, 16, v34
    v_rcp_f32 v34, v34
    v_lshlrev_b32 v48, 16, v40
    v_and_b32 v49, s62, v40
    v_sub_f32 v48, v48, v32
    v_sub_f32 v49, v49, v32
    v_cvt_pk_bf16_f32 v50, v48, v49
    v_lshlrev_b32 v48, 16, v50
    v_and_b32 v49, s62, v50
    v_mul_f32 v48, v48, v34
    v_mul_f32 v49, v49, v34
    v_cvt_pk_bf16_f32 v16, v48, v49
    v_lshlrev_b32 v48, 16, v41
    v_and_b32 v49, s62, v41
    v_sub_f32 v48, v48, v32
    v_sub_f32 v49, v49, v32
    v_cvt_pk_bf16_f32 v50, v48, v49
    v_lshlrev_b32 v48, 16, v50
    v_and_b32 v49, s62, v50
    v_mul_f32 v48, v48, v34
    v_mul_f32 v49, v49, v34
    v_cvt_pk_bf16_f32 v17, v48, v49
    v_lshlrev_b32 v48, 16, v42
    v_and_b32 v49, s62, v42
    v_sub_f32 v48, v48, v32
    v_sub_f32 v49, v49, v32
    v_cvt_pk_bf16_f32 v50, v48, v49
    v_lshlrev_b32 v48, 16, v50
    v_and_b32 v49, s62, v50
    v_mul_f32 v48, v48, v34
    v_mul_f32 v49, v49, v34
    v_cvt_pk_bf16_f32 v18, v48, v49
    v_lshlrev_b32 v48, 16, v43
    v_and_b32 v49, s62, v43
    v_sub_f32 v48, v48, v32
    v_sub_f32 v49, v49, v32
    v_cvt_pk_bf16_f32 v50, v48, v49
    v_lshlrev_b32 v48, 16, v50
    v_and_b32 v49, s62, v50
    v_mul_f32 v48, v48, v34
    v_mul_f32 v49, v49, v34
    v_cvt_pk_bf16_f32 v19, v48, v49
    v_mov_b32 v48, 0
    v_mov_b32 v49, 0
    v_mov_b32 v50, 0
    v_mov_b32 v51, 0
    v_mov_b32 v52, 0
    v_mov_b32 v53, 0
    v_mov_b32 v54, 0
    v_mov_b32 v55, 0
    s_lshl_b32 s5, s54, 10
    v_lshl_add_u32 v12, v12, 1, v3
    v_add_u32 v12, s5, v12
    v_lshlrev_b32 v20, 3, v1
    v_lshrrev_b32 v21, 3, v1
    v_lshl_add_u32 v21, v21, 11, v4
    v_mov_b32 v23, 0x80
    s_waitcnt vmcnt(6)
    v_perm_b32 v44, v68, v64, s60
    v_perm_b32 v45, v68, v64, s61
    v_dot2c_f32_bf16 v48, v44, v16
    v_dot2c_f32_bf16 v49, v45, v16
    v_perm_b32 v46, v69, v65, s60
    v_perm_b32 v47, v69, v65, s61
    v_dot2c_f32_bf16 v50, v46, v16
    v_dot2c_f32_bf16 v51, v47, v16
    v_perm_b32 v44, v70, v66, s60
    v_perm_b32 v45, v70, v66, s61
    v_dot2c_f32_bf16 v52, v44, v16
    v_dot2c_f32_bf16 v53, v45, v16
    v_perm_b32 v46, v71, v67, s60
    v_perm_b32 v47, v71, v67, s61
    v_dot2c_f32_bf16 v54, v46, v16
    v_dot2c_f32_bf16 v55, v47, v16
    s_waitcnt vmcnt(4)
    v_perm_b32 v44, v76, v72, s60
    v_perm_b32 v45, v76, v72, s61
    v_dot2c_f32_bf16 v48, v44, v17
    v_dot2c_f32_bf16 v49, v45, v17
    v_perm_b32 v46, v77, v73, s60
    v_perm_b32 v47, v77, v73, s61
    v_dot2c_f32_bf16 v50, v46, v17
    v_dot2c_f32_bf16 v51, v47, v17
    v_perm_b32 v44, v78, v74, s60
    v_perm_b32 v45, v78, v74, s61
    v_dot2c_f32_bf16 v52, v44, v17
    v_dot2c_f32_bf16 v53, v45, v17
    v_perm_b32 v46, v79, v75, s60
    v_perm_b32 v47, v79, v75, s61
    v_dot2c_f32_bf16 v54, v46, v17
    v_dot2c_f32_bf16 v55, v47, v17
    s_waitcnt vmcnt(2)
    v_perm_b32 v44, v84, v80, s60
    v_perm_b32 v45, v84, v80, s61
    v_dot2c_f32_bf16 v48, v44, v18
    v_dot2c_f32_bf16 v49, v45, v18
    v_perm_b32 v46, v85, v81, s60
    v_perm_b32 v47, v85, v81, s61
    v_dot2c_f32_bf16 v50, v46, v18
    v_dot2c_f32_bf16 v51, v47, v18
    v_perm_b32 v44, v86, v82, s60
    v_perm_b32 v45, v86, v82, s61
    v_dot2c_f32_bf16 v52, v44, v18
    v_dot2c_f32_bf16 v53, v45, v18
    v_perm_b32 v46, v87, v83, s60
    v_perm_b32 v47, v87, v83, s61
    v_dot2c_f32_bf16 v54, v46, v18
    v_dot2c_f32_bf16 v55, v47, v18
    s_waitcnt vmcnt(0)
    v_perm_b32 v44, v92, v88, s60
    v_perm_b32 v45, v92, v88, s61
    v_dot2c_f32_bf16 v48, v44, v19
    v_dot2c_f32_bf16 v49, v45, v19
    v_perm_b32 v46, v93, v89, s60
    v_perm_b32 v47, v93, v89, s61
    v_dot2c_f32_bf16 v50, v46, v19
    v_dot2c_f32_bf16 v51, v47, v19
    v_perm_b32 v44, v94, v90, s60
    v_perm_b32 v45, v94, v90, s61
    v_dot2c_f32_bf16 v52, v44, v19
    v_dot2c_f32_bf16 v53, v45, v19
    v_perm_b32 v46, v95, v91, s60
    v_perm_b32 v47, v95, v91, s61
    v_dot2c_f32_bf16 v54, v46, v19
    v_dot2c_f32_bf16 v55, v47, v19
    s_nop 2
    v_permlane32_swap_b32 v48, v52
    v_permlane32_swap_b32 v49, v53
    v_permlane32_swap_b32 v50, v54
    v_permlane32_swap_b32 v51, v55
    v_add_f32 v48, v48, v52
    v_add_f32 v49, v49, v53
    v_add_f32 v50, v50, v54
    v_add_f32 v51, v51, v55
    ds_write_b128 v12, v[48:51] offset:25600
    s_mov_b64 exec, 1
    ds_add_rtn_u32 v47, v14, v15 offset:0
    s_waitcnt lgkmcnt(0)
    v_readfirstlane_b32 s56, v47
    s_mov_b64 exec, -1
    s_mul_i32 s49, s49, 1664525
    s_add_u32 s49, s49, 1013904223
    s_and_b32 s89, s49, 0xffff
    v_mov_b32 v22, s49
    s_mov_b32 s96, s56
    s_cmp_lg_u32 s56, 3
    s_cbranch_scc1 L_q_done
    ds_read_b128 v[64:67], v8 offset:25600
    ds_read_b128 v[68:71], v8 offset:26624
    ds_read_b128 v[72:75], v8 offset:27648
    ds_read_b128 v[76:79], v8 offset:28672
    s_lshr_b32 s5, s48, 4
    s_lshl_b32 s5, s5, 14
    s_lshl_b32 s6, s53, 7
    s_add_u32 s5, s5, s6
    s_add_u32 s5, s5, 262144
    s_waitcnt lgkmcnt(0)
    v_add_f32 v64, v64, v68
    v_add_f32 v72, v72, v76
    v_add_f32 v65, v65, v69
    v_add_f32 v73, v73, v77
    v_add_f32 v66, v66, v70
    v_add_f32 v74, v74, v78
    v_add_f32 v67, v67, v71
    v_add_f32 v75, v75, v79
    v_add_f32 v64, v64, v72
    v_add_f32 v65, v65, v73
    v_add_f32 v66, v66, v74
    v_add_f32 v67, v67, v75
    v_add_u32 v64, v23, v64
    v_add_u32 v65, v23, v65
    v_add_u32 v66, v23, v66
    v_add_u32 v67, v23, v67
    v_perm_b32 v48, v64, v65, s90
    v_perm_b32 v49, v65, v22, s91
    v_perm_b32 v50, v66, v67, s90
    v_perm_b32 v51, v67, v22, s91
    buffer_store_dwordx4 v[48:51], v21, s[44:47], s5 offen sc1
    s_mov_b32 s58, 1000000
    s_cmp_ge_u32 s53, 8
    s_cbranch_scc1 L_q_done
    s_and_b32 s5, s48, 15
    s_cbranch_scc1 L_noinit
    s_lshr_b32 s5, s48, 4
    s_mul_i32 s5, s5, 4352
    s_add_u32 s5, s5, 3145728
    s_movk_i32 s56, 4352
    v_mul_u32_u24 v56, s56, v1
    s_mov_b64 exec, 1
    buffer_store_dword v14, v56, s[44:47], s5 offen sc1
    s_mov_b64 exec, -1
L_noinit:
    s_lshl_b32 s5, s88, 11
    s_add_u32 s5, s5, 262144
    s_waitcnt vmcnt(0)
L_xq_poll:
    buffer_load_dwordx4 v[64:67], v8, s[44:47], s5 offen sc1
    buffer_load_dwordx4 v[68:71], v8, s[44:47], s5 offen offset:1024 sc1
    s_sub_u32 s58, s58, 1
    s_cbranch_scc1 L_end
    s_waitcnt vmcnt(0)
    v_cmp_ne_u16 vcc, s89, v65
    v_cmp_ne_u16 s[56:57], s89, v67
    s_nop 0
    s_or_b64 vcc, vcc, s[56:57]
    v_cmp_ne_u16 s[56:57], s89, v69
    s_nop 0
    s_or_b64 vcc, vcc, s[56:57]
    v_cmp_ne_u16 s[56:57], s89, v71
    s_nop 0
    s_or_b64 vcc, vcc, s[56:57]
    s_cbranch_scc1 L_xq_poll
    v_perm_b32 v65, v65, v64, s94
    v_and_b32 v64, s95, v64
    v_perm_b32 v67, v67, v66, s94
    v_and_b32 v66, s95, v66
    v_perm_b32 v69, v69, v68, s94
    v_and_b32 v68, s95, v68
    v_perm_b32 v71, v71, v70, s94
    v_and_b32 v70, s95, v70
    v_add_f32 v64, v64, v68
    v_add_f32 v65, v65, v69
    v_add_f32 v66, v66, v70
    v_add_f32 v67, v67, v71
    v_add_f32_dpp v64, v64, v64 row_ror:8 row_mask:0xf bank_mask:0xf
    v_add_f32_dpp v65, v65, v65 row_ror:8 row_mask:0xf bank_mask:0xf
    v_add_f32_dpp v66, v66, v66 row_ror:8 row_mask:0xf bank_mask:0xf
    v_add_f32_dpp v67, v67, v67 row_ror:8 row_mask:0xf bank_mask:0xf
    v_mov_b32 v68, v64
    s_nop 1
    v_permlane16_swap_b32 v64, v68
    v_add_f32 v64, v64, v68
    v_mov_b32 v68, v64
    s_nop 1
    v_permlane32_swap_b32 v64, v68
    v_add_f32 v64, v64, v68
    v_mov_b32 v69, v65
    s_nop 1
    v_permlane16_swap_b32 v65, v69
    v_add_f32 v65, v65, v69
    v_mov_b32 v69, v65
    s_nop 1
    v_permlane32_swap_b32 v65, v69
    v_add_f32 v65, v65, v69
    v_mov_b32 v70, v66
    s_nop 1
    v_permlane16_swap_b32 v66, v70
    v_add_f32 v66, v66, v70
    v_mov_b32 v70, v66
    s_nop 1
    v_permlane32_swap_b32 v66, v70
    v_add_f32 v66, v66, v70
    v_mov_b32 v71, v67
    s_nop 1
    v_permlane16_swap_b32 v67, v71
    v_add_f32 v67, v67, v71
    v_mov_b32 v71, v67
    s_nop 1
    v_permlane32_swap_b32 v67, v71
    v_add_f32 v67, v67, v71
    v_cvt_pk_bf16_f32 v52, v64, v65
    v_mov_b32 v53, v22
    v_cvt_pk_bf16_f32 v54, v66, v67
    v_mov_b32 v55, v22
    s_lshl_b32 s5, s88, 7
    s_add_u32 s5, s5, 4096
    s_mov_b64 exec, 0xff
    buffer_store_dwordx4 v[52:55], v8, s[44:47], s5 offen sc1
    s_mov_b64 exec, -1
L_q_done:
    s_setprio 1
    s_mul_i32 s5, s97, 7168
    s_lshl_b32 s6, s52, 9
    s_add_u32 s5, s5, s6
    s_add_u32 s6, s5, 0
    buffer_load_dwordx4 v[64:67], v6, s[28:31], s6 offen nt
    s_add_u32 s6, s5, 0
    buffer_load_dwordx4 v[96:99], v6, s[32:35], s6 offen nt
    s_add_u32 s6, s5, 7168
    buffer_load_dwordx4 v[68:71], v6, s[28:31], s6 offen nt
    s_waitcnt vmcnt(2)
    s_add_u32 s6, s5, 7168
    buffer_load_dwordx4 v[100:103], v6, s[32:35], s6 offen nt
    s_waitcnt vmcnt(2)
    s_add_u32 s6, s5, 14336
    buffer_load_dwordx4 v[72:75], v6, s[28:31], s6 offen nt
    s_waitcnt vmcnt(2)
    s_add_u32 s6, s5, 14336
    buffer_load_dwordx4 v[104:107], v6, s[32:35], s6 offen nt
    s_waitcnt vmcnt(2)
    s_add_u32 s6, s5, 21504
    buffer_load_dwordx4 v[76:79], v6, s[28:31], s6 offen nt
    s_waitcnt vmcnt(2)
    s_add_u32 s6, s5, 21504
    buffer_load_dwordx4 v[108:111], v6, s[32:35], s6 offen nt
    s_waitcnt vmcnt(2)
    s_add_u32 s6, s5, 28672
    buffer_load_dwordx4 v[80:83], v6, s[28:31], s6 offen nt
    s_waitcnt vmcnt(2)
    s_add_u32 s6, s5, 28672
    buffer_load_dwordx4 v[112:115], v6, s[32:35], s6 offen nt
    s_waitcnt vmcnt(2)
    s_add_u32 s6, s5, 35840
    buffer_load_dwordx4 v[84:87], v6, s[28:31], s6 offen nt
    s_waitcnt vmcnt(2)
    s_add_u32 s6, s5, 35840
    buffer_load_dwordx4 v[116:119], v6, s[32:35], s6 offen nt
    s_waitcnt vmcnt(2)
    s_add_u32 s6, s5, 43008
    buffer_load_dwordx4 v[88:91], v6, s[28:31], s6 offen nt
    s_waitcnt vmcnt(2)
    s_add_u32 s6, s5, 43008
    buffer_load_dwordx4 v[120:123], v6, s[32:35], s6 offen nt
    s_waitcnt vmcnt(2)
    s_add_u32 s6, s5, 50176
    buffer_load_dwordx4 v[92:95], v6, s[28:31], s6 offen nt
    s_waitcnt vmcnt(2)
    s_add_u32 s6, s5, 50176
    buffer_load_dwordx4 v[124:127], v6, s[32:35], s6 offen nt
    s_cmp_lg_u32 s96, 0
    s_cbranch_scc1 L_qg_done
    s_mov_b32 s58, 4000000
L_sp6:
    ds_read_b32 v47, v14 offset:44
    s_sub_u32 s58, s58, 1
    s_cbranch_scc1 L_end
    s_waitcnt lgkmcnt(0)
    v_readfirstlane_b32 s56, v47
    s_nop 0
    s_cmp_ge_u32 s56, 1
    s_cbranch_scc1 L_sd6
    s_sleep 2
    s_branch L_sp6
L_sd6:
    s_lshl_b32 s5, s50, 12
    s_add_u32 s5, s5, 4096
    s_mov_b32 s58, 1000000
    s_branch L_q_first
L_q_poll:
    s_sleep 8
L_q_first:
    buffer_load_dwordx4 v[128:131], v8, s[44:47], s5 offen offset:0 sc1
    buffer_load_dwordx4 v[132:135], v8, s[44:47], s5 offen offset:1024 sc1
    buffer_load_dwordx4 v[136:139], v8, s[44:47], s5 offen offset:2048 sc1
    buffer_load_dwordx4 v[140:143], v8, s[44:47], s5 offen offset:3072 sc1
    s_sub_u32 s58, s58, 1
    s_cbranch_scc1 L_end
    s_waitcnt vmcnt(0)
    v_cmp_ne_u32 vcc, s49, v129
    v_cmp_ne_u32 s[56:57], s49, v131
    s_nop 0
    s_or_b64 vcc, vcc, s[56:57]
    v_cmp_ne_u32 s[56:57], s49, v133
    s_nop 0
    s_or_b64 vcc, vcc, s[56:57]
    v_cmp_ne_u32 s[56:57], s49, v135
    s_nop 0
    s_or_b64 vcc, vcc, s[56:57]
    v_cmp_ne_u32 s[56:57], s49, v137
    s_nop 0
    s_or_b64 vcc, vcc, s[56:57]
    v_cmp_ne_u32 s[56:57], s49, v139
    s_nop 0
    s_or_b64 vcc, vcc, s[56:57]
    v_cmp_ne_u32 s[56:57], s49, v141
    s_nop 0
    s_or_b64 vcc, vcc, s[56:57]
    v_cmp_ne_u32 s[56:57], s49, v143
    s_nop 0
    s_or_b64 vcc, vcc, s[56:57]
    s_cbranch_scc1 L_q_poll
    v_mov_b32 v129, v130
    ds_write_b64 v20, v[128:129] offset:4096
    v_mov_b32 v133, v134
    ds_write_b64 v20, v[132:133] offset:4608
    v_mov_b32 v137, v138
    ds_write_b64 v20, v[136:137] offset:5120
    v_mov_b32 v141, v142
    ds_write_b64 v20, v[140:141] offset:5632
    ds_write_b32 v14, v22 offset:192
    ds_write_b32 v14, v15 offset:8
L_qg_done:
    s_cmp_eq_u32 s55, 0
    s_cbranch_scc1 L_h_done
    v_mov_b32 v48, 0
    v_mov_b32 v49, 0
    v_mov_b32 v50, 0
    v_mov_b32 v51, 0
    v_mov_b32 v52, 0
    v_mov_b32 v53, 0
    v_mov_b32 v54, 0
    v_mov_b32 v55, 0
    v_mov_b32 v56, 0
    v_mov_b32 v57, 0
    v_mov_b32 v58, 0
    v_mov_b32 v59, 0
    v_mov_b32 v60, 0
    v_mov_b32 v61, 0
    v_mov_b32 v62, 0
    v_mov_b32 v63, 0
    s_waitcnt vmcnt(0)
    v_perm_b32 v44, v68, v64, s60
    v_perm_b32 v45, v68, v64, s61
    v_dot2c_f32_bf16 v48, v44, v16
    v_dot2c_f32_bf16 v49, v45, v16
    v_perm_b32 v46, v69, v65, s60
    v_perm_b32 v47, v69, v65, s61
    v_dot2c_f32_bf16 v50, v46, v16
    v_dot2c_f32_bf16 v51, v47, v16
    v_perm_b32 v44, v70, v66, s60
    v_perm_b32 v45, v70, v66, s61
    v_dot2c_f32_bf16 v52, v44, v16
    v_dot2c_f32_bf16 v53, v45, v16
    v_perm_b32 v46, v71, v67, s60
    v_perm_b32 v47, v71, v67, s61
    v_dot2c_f32_bf16 v54, v46, v16
    v_dot2c_f32_bf16 v55, v47, v16
    v_perm_b32 v44, v76, v72, s60
    v_perm_b32 v45, v76, v72, s61
    v_dot2c_f32_bf16 v48, v44, v17
    v_dot2c_f32_bf16 v49, v45, v17
    v_perm_b32 v46, v77, v73, s60
    v_perm_b32 v47, v77, v73, s61
    v_dot2c_f32_bf16 v50, v46, v17
    v_dot2c_f32_bf16 v51, v47, v17
    v_perm_b32 v44, v78, v74, s60
    v_perm_b32 v45, v78, v74, s61
    v_dot2c_f32_bf16 v52, v44, v17
    v_dot2c_f32_bf16 v53, v45, v17
    v_perm_b32 v46, v79, v75, s60
    v_perm_b32 v47, v79, v75, s61
    v_dot2c_f32_bf16 v54, v46, v17
    v_dot2c_f32_bf16 v55, v47, v17
    v_perm_b32 v44, v84, v80, s60
    v_perm_b32 v45, v84, v80, s61
    v_dot2c_f32_bf16 v48, v44, v18
    v_dot2c_f32_bf16 v49, v45, v18
    v_perm_b32 v46, v85, v81, s60
    v_perm_b32 v47, v85, v81, s61
    v_dot2c_f32_bf16 v50, v46, v18
    v_dot2c_f32_bf16 v51, v47, v18
    v_perm_b32 v44, v86, v82, s60
    v_perm_b32 v45, v86, v82, s61
    v_dot2c_f32_bf16 v52, v44, v18
    v_dot2c_f32_bf16 v53, v45, v18
    v_perm_b32 v46, v87, v83, s60
    v_perm_b32 v47, v87, v83, s61
    v_dot2c_f32_bf16 v54, v46, v18
    v_dot2c_f32_bf16 v55, v47, v18
    v_perm_b32 v44, v92, v88, s60
    v_perm_b32 v45, v92, v88, s61
    v_dot2c_f32_bf16 v48, v44, v19
    v_dot2c_f32_bf16 v49, v45, v19
    v_perm_b32 v46, v93, v89, s60
    v_perm_b32 v47, v93, v89, s61
    v_dot2c_f32_bf16 v50, v46, v19
    v_dot2c_f32_bf16 v51, v47, v19
    v_perm_b32 v44, v94, v90, s60
    v_perm_b32 v45, v94, v90, s61
    v_dot2c_f32_bf16 v52, v44, v19
    v_dot2c_f32_bf16 v53, v45, v19
    v_perm_b32 v46, v95, v91, s60
    v_perm_b32 v47, v95, v91, s61
    v_dot2c_f32_bf16 v54, v46, v19
    v_dot2c_f32_bf16 v55, v47, v19
    v_perm_b32 v44, v100, v96, s60
    v_perm_b32 v45, v100, v96, s61
    v_dot2c_f32_bf16 v56, v44, v16
    v_dot2c_f32_bf16 v57, v45, v16
    v_perm_b32 v46, v101, v97, s60
    v_perm_b32 v47, v101, v97, s61
    v_dot2c_f32_bf16 v58, v46, v16
    v_dot2c_f32_bf16 v59, v47, v16
    v_perm_b32 v44, v102, v98, s60
    v_perm_b32 v45, v102, v98, s61
    v_dot2c_f32_bf16 v60, v44, v16
    v_dot2c_f32_bf16 v61, v45, v16
    v_perm_b32 v46, v103, v99, s60
    v_perm_b32 v47, v103, v99, s61
    v_dot2c_f32_bf16 v62, v46, v16
    v_dot2c_f32_bf16 v63, v47, v16
    v_perm_b32 v44, v108, v104, s60
    v_perm_b32 v45, v108, v104, s61
    v_dot2c_f32_bf16 v56, v44, v17
    v_dot2c_f32_bf16 v57, v45, v17
    v_perm_b32 v46, v109, v105, s60
    v_perm_b32 v47, v109, v105, s61
    v_dot2c_f32_bf16 v58, v46, v17
    v_dot2c_f32_bf16 v59, v47, v17
    v_perm_b32 v44, v110, v106, s60
    v_perm_b32 v45, v110, v106, s61
    v_dot2c_f32_bf16 v60, v44, v17
    v_dot2c_f32_bf16 v61, v45, v17
    v_perm_b32 v46, v111, v107, s60
    v_perm_b32 v47, v111, v107, s61
    v_dot2c_f32_bf16 v62, v46, v17
    v_dot2c_f32_bf16 v63, v47, v17
    v_perm_b32 v44, v116, v112, s60
    v_perm_b32 v45, v116, v112, s61
    v_dot2c_f32_bf16 v56, v44, v18
    v_dot2c_f32_bf16 v57, v45, v18
    v_perm_b32 v46, v117, v113, s60
    v_perm_b32 v47, v117, v113, s61
    v_dot2c_f32_bf16 v58, v46, v18
    v_dot2c_f32_bf16 v59, v47, v18
    v_perm_b32 v44, v118, v114, s60
    v_perm_b32 v45, v118, v114, s61
    v_dot2c_f32_bf16 v60, v44, v18
    v_dot2c_f32_bf16 v61, v45, v18
    v_perm_b32 v46, v119, v115, s60
    v_perm_b32 v47, v119, v115, s61
    v_dot2c_f32_bf16 v62, v46, v18
    v_dot2c_f32_bf16 v63, v47, v18
    v_perm_b32 v44, v124, v120, s60
    v_perm_b32 v45, v124, v120, s61
    v_dot2c_f32_bf16 v56, v44, v19
    v_dot2c_f32_bf16 v57, v45, v19
    v_perm_b32 v46, v125, v121, s60
    v_perm_b32 v47, v125, v121, s61
    v_dot2c_f32_bf16 v58, v46, v19
    v_dot2c_f32_bf16 v59, v47, v19
    v_perm_b32 v44, v126, v122, s60
    v_perm_b32 v45, v126, v122, s61
    v_dot2c_f32_bf16 v60, v44, v19
    v_dot2c_f32_bf16 v61, v45, v19
    v_perm_b32 v46, v127, v123, s60
    v_perm_b32 v47, v127, v123, s61
    v_dot2c_f32_bf16 v62, v46, v19
    v_dot2c_f32_bf16 v63, v47, v19
    s_nop 2
    v_permlane32_swap_b32 v48, v52
    v_permlane32_swap_b32 v49, v53
    v_permlane32_swap_b32 v50, v54
    v_permlane32_swap_b32 v51, v55
    v_add_f32 v48, v48, v52
    v_add_f32 v49, v49, v53
    v_add_f32 v50, v50, v54
    v_add_f32 v51, v51, v55
    ds_write_b128 v12, v[48:51] offset:29696
    v_permlane32_swap_b32 v56, v60
    v_permlane32_swap_b32 v57, v61
    v_permlane32_swap_b32 v58, v62
    v_permlane32_swap_b32 v59, v63
    v_add_f32 v56, v56, v60
    v_add_f32 v57, v57, v61
    v_add_f32 v58, v58, v62
    v_add_f32 v59, v59, v63
    ds_write_b128 v12, v[56:59] offset:33792
    s_mov_b64 exec, 1
    ds_add_rtn_u32 v47, v14, v15 offset:4
    s_waitcnt lgkmcnt(0)
    v_readfirstlane_b32 s56, v47
    s_mov_b64 exec, -1
    s_cmp_lg_u32 s56, 3
    s_cbranch_scc1 L_h_done
    ds_read_b64 v[64:65], v20 offset:29696
    ds_read_b64 v[72:73], v20 offset:33792
    ds_read_b64 v[66:67], v20 offset:30720
    ds_read_b64 v[74:75], v20 offset:34816
    ds_read_b64 v[68:69], v20 offset:31744
    ds_read_b64 v[76:77], v20 offset:35840
    ds_read_b64 v[70:71], v20 offset:32768
    ds_read_b64 v[78:79], v20 offset:36864
    ds_read_b64 v[80:81], v20 offset:30208
    ds_read_b64 v[88:89], v20 offset:34304
    ds_read_b64 v[82:83], v20 offset:31232
    ds_read_b64 v[90:91], v20 offset:35328
    ds_read_b64 v[84:85], v20 offset:32256
    ds_read_b64 v[92:93], v20 offset:36352
    ds_read_b64 v[86:87], v20 offset:33280
    ds_read_b64 v[94:95], v20 offset:37376
    s_lshl_b32 s5, s52, 15
    s_lshl_b32 s6, s53, 7
    s_add_u32 s5, s5, s6
    s_add_u32 s5, s5, 524288
    s_waitcnt lgkmcnt(0)
    v_add_f32 v64, v64, v66
    v_add_f32 v65, v65, v67
    v_add_f32 v68, v68, v70
    v_add_f32 v69, v69, v71
    v_add_f32 v72, v72, v74
    v_add_f32 v73, v73, v75
    v_add_f32 v76, v76, v78
    v_add_f32 v77, v77, v79
    v_add_f32 v56, v64, v68
    v_add_f32 v57, v72, v76
    v_add_f32 v58, v65, v69
    v_add_f32 v59, v73, v77
    v_add_u32 v56, v23, v56
    v_add_u32 v57, v23, v57
    v_add_u32 v58, v23, v58
    v_add_u32 v59, v23, v59
    v_perm_b32 v48, v56, v57, s90
    v_perm_b32 v49, v57, v22, s91
    v_perm_b32 v50, v58, v59, s90
    v_perm_b32 v51, v59, v22, s91
    buffer_store_dwordx4 v[48:51], v21, s[44:47], s5 offen sc1
    s_add_u32 s5, s5, 16384
    v_add_f32 v80, v80, v82
    v_add_f32 v81, v81, v83
    v_add_f32 v84, v84, v86
    v_add_f32 v85, v85, v87
    v_add_f32 v88, v88, v90
    v_add_f32 v89, v89, v91
    v_add_f32 v92, v92, v94
    v_add_f32 v93, v93, v95
    v_add_f32 v56, v80, v84
    v_add_f32 v57, v88, v92
    v_add_f32 v58, v81, v85
    v_add_f32 v59, v89, v93
    v_add_u32 v56, v23, v56
    v_add_u32 v57, v23, v57
    v_add_u32 v58, v23, v58
    v_add_u32 v59, v23, v59
    v_perm_b32 v52, v56, v57, s90
    v_perm_b32 v53, v57, v22, s91
    v_perm_b32 v54, v58, v59, s90
    v_perm_b32 v55, v59, v22, s91
    buffer_store_dwordx4 v[52:55], v21, s[44:47], s5 offen sc1
    s_lshl_b32 s5, s52, 15
    s_and_b32 s6, s53, 7
    s_lshl_b32 s6, s6, 12
    s_add_u32 s5, s5, s6
    s_add_u32 s5, s5, 524288
    s_mov_b32 s58, 4000000
L_sp7:
    ds_read_b32 v47, v14 offset:36
    s_sub_u32 s58, s58, 1
    s_cbranch_scc1 L_end
    s_waitcnt lgkmcnt(0)
    v_readfirstlane_b32 s56, v47
    s_nop 0
    s_cmp_eq_u32 s56, 4
    s_cbranch_scc1 L_sd7
    s_sleep 8
    s_branch L_sp7
L_sd7:
    s_mov_b32 s58, 1000000
    s_branch L_xh_first
L_xh_poll:
    s_sleep 16
L_xh_first:
    buffer_load_dwordx4 v[64:67], v8, s[44:47], s5 offen offset:0 sc1
    buffer_load_dwordx4 v[68:71], v8, s[44:47], s5 offen offset:1024 sc1
    buffer_load_dwordx4 v[72:75], v8, s[44:47], s5 offen offset:2048 sc1
    buffer_load_dwordx4 v[76:79], v8, s[44:47], s5 offen offset:3072 sc1
    s_sub_u32 s58, s58, 1
    s_cbranch_scc1 L_end
    s_waitcnt vmcnt(0)
    v_cmp_ne_u16 vcc, s89, v65
    v_cmp_ne_u16 s[56:57], s89, v67
    s_nop 0
    s_or_b64 vcc, vcc, s[56:57]
    v_cmp_ne_u16 s[56:57], s89, v69
    s_nop 0
    s_or_b64 vcc, vcc, s[56:57]
    v_cmp_ne_u16 s[56:57], s89, v71
    s_nop 0
    s_or_b64 vcc, vcc, s[56:57]
    v_cmp_ne_u16 s[56:57], s89, v73
    s_nop 0
    s_or_b64 vcc, vcc, s[56:57]
    v_cmp_ne_u16 s[56:57], s89, v75
    s_nop 0
    s_or_b64 vcc, vcc, s[56:57]
    v_cmp_ne_u16 s[56:57], s89, v77
    s_nop 0
    s_or_b64 vcc, vcc, s[56:57]
    v_cmp_ne_u16 s[56:57], s89, v79
    s_nop 0
    s_or_b64 vcc, vcc, s[56:57]
    s_cbranch_scc1 L_xh_poll
    s_cmp_lg_u32 s48, 0
    s_cbranch_scc1 L_noepoch
    s_mov_b64 exec, 1
    buffer_store_dword v22, v14, s[44:47], 0 offen offset:4 sc1
    s_mov_b64 exec, -1
L_noepoch:
    v_perm_b32 v65, v65, v64, s94
    v_and_b32 v64, s95, v64
    v_perm_b32 v67, v67, v66, s94
    v_and_b32 v66, s95, v66
    v_perm_b32 v69, v69, v68, s94
    v_and_b32 v68, s95, v68
    v_perm_b32 v71, v71, v70, s94
    v_and_b32 v70, s95, v70
    v_perm_b32 v73, v73, v72, s94
    v_and_b32 v72, s95, v72
    v_perm_b32 v75, v75, v74, s94
    v_and_b32 v74, s95, v74
    v_perm_b32 v77, v77, v76, s94
    v_and_b32 v76, s95, v76
    v_perm_b32 v79, v79, v78, s94
    v_and_b32 v78, s95, v78
    v_add_f32 v64, v64, v68
    v_add_f32 v72, v72, v76
    v_add_f32 v65, v65, v69
    v_add_f32 v73, v73, v77
    v_add_f32 v66, v66, v70
    v_add_f32 v74, v74, v78
    v_add_f32 v67, v67, v71
    v_add_f32 v75, v75, v79
    v_permlane32_swap_b32 v64, v72
    v_permlane32_swap_b32 v65, v73
    v_permlane32_swap_b32 v66, v74
    v_permlane32_swap_b32 v67, v75
    v_add_f32 v64, v64, v72
    v_add_f32 v65, v65, v73
    v_add_f32 v66, v66, v74
    v_add_f32 v67, v67, v75
    v_add_f32_dpp v64, v64, v64 row_ror:8 row_mask:0xf bank_mask:0xf
    v_add_f32_dpp v65, v65, v65 row_ror:8 row_mask:0xf bank_mask:0xf
    v_add_f32_dpp v66, v66, v66 row_ror:8 row_mask:0xf bank_mask:0xf
    v_add_f32_dpp v67, v67, v67 row_ror:8 row_mask:0xf bank_mask:0xf
    v_mov_b32 v68, v64
    v_mov_b32 v69, v65
    v_mov_b32 v70, v66
    v_mov_b32 v71, v67
    v_permlane16_swap_b32 v64, v68
    v_permlane16_swap_b32 v65, v69
    v_permlane16_swap_b32 v66, v70
    v_permlane16_swap_b32 v67, v71
    v_add_f32 v64, v64, v68
    v_add_f32 v65, v65, v69
    v_add_f32 v66, v66, v70
    v_add_f32 v67, v67, v71
    v_cvt_pk_bf16_f32 v64, v64, v64
    v_lshlrev_b32 v64, 16, v64
    v_cvt_pk_bf16_f32 v65, v65, v65
    v_lshlrev_b32 v65, 16, v65
    v_mul_f32 v68, s63, v64
    v_exp_f32 v68, -v68
    s_nop 0
    v_add_f32 v68, 1.0, v68
    v_rcp_f32 v68, v68
    s_nop 0
    v_mul_f32 v64, v64, v68
    v_cvt_pk_bf16_f32 v64, v64, v64
    v_lshlrev_b32 v64, 16, v64
    v_mul_f32 v64, v64, v65
    v_cvt_pk_bf16_f32 v66, v66, v66
    v_lshlrev_b32 v66, 16, v66
    v_cvt_pk_bf16_f32 v67, v67, v67
    v_lshlrev_b32 v67, 16, v67
    v_mul_f32 v69, s63, v66
    v_exp_f32 v69, -v69
    s_nop 0
    v_add_f32 v69, 1.0, v69
    v_rcp_f32 v69, v69
    s_nop 0
    v_mul_f32 v66, v66, v69
    v_cvt_pk_bf16_f32 v66, v66, v66
    v_lshlrev_b32 v66, 16, v66
    v_mul_f32 v66, v66, v67
    v_cvt_pk_bf16_f32 v64, v64, v66
    v_lshrrev_b32 v65, 2, v4
    v_lshl_add_u32 v65, v3, 1, v65
    s_mov_b32 exec_lo, 0xff
    s_mov_b32 exec_hi, 0xff
    ds_write_b32 v65, v64 offset:64
    s_mov_b64 exec, 1
    ds_write_b32 v14, v15 offset:24
    s_mov_b64 exec, -1
L_h_done:
    v_lshlrev_b32 v11, 14, v9
    v_lshl_add_u32 v11, v10, 4, v11
    v_lshlrev_b32 v2, 4, v9
    s_lshr_b32 s6, s53, 3
    s_lshl_b32 s6, s6, 2
    s_add_u32 s92, s6, s54
    s_lshl_b32 s6, s92, 8
    s_lshl_b32 s5, s88, 16
    s_add_u32 s5, s5, s6
    s_lshl_b32 s7, s52, 3
    s_and_b32 s93, s53, 7
    s_add_u32 s7, s7, s93
    s_lshl_b32 s7, s7, 16
    s_add_u32 s7, s7, s6
    v_lshrrev_b32 v6, 2, v10
    v_lshlrev_b32 v6, 14, v6
    v_lshl_add_u32 v6, v3, 2, v6
    v_and_b32 v5, 3, v1
    v_lshl_add_u32 v6, v5, 4, v6
    s_lshl_b32 s92, s92, 16
    s_lshl_b32 s93, s88, 7
    s_add_u32 s92, s92, s93
    s_add_u32 s92, s92, 2097152
    v_mov_b32 v48, 0
    v_mov_b32 v49, 0
    v_mov_b32 v50, 0
    v_mov_b32 v51, 0
    v_mov_b32 v52, 0
    v_mov_b32 v53, 0
    v_mov_b32 v54, 0
    v_mov_b32 v55, 0
    s_mov_b32 s58, 4000000
L_sp8:
    ds_read_b32 v47, v14 offset:12
    s_sub_u32 s58, s58, 1
    s_cbranch_scc1 L_end
    s_waitcnt lgkmcnt(0)
    v_readfirstlane_b32 s56, v47
    s_nop 0
    s_cmp_ge_u32 s56, 4
    s_cbranch_scc1 L_sd8
    s_sleep 2
    s_branch L_sp8
L_sd8:
    buffer_load_dwordx4 v[64:67], v11, s[36:39], s7 offen offset:0 nt
    buffer_load_dwordx4 v[68:71], v11, s[36:39], s7 offen offset:2048 nt
    s_add_u32 s7, s7, 4096
    buffer_load_dwordx4 v[72:75], v11, s[36:39], s7 offen offset:0 nt
    buffer_load_dwordx4 v[76:79], v11, s[36:39], s7 offen offset:2048 nt
    s_add_u32 s7, s7, 4096
    buffer_load_dwordx4 v[80:83], v11, s[36:39], s7 offen offset:0 nt
    buffer_load_dwordx4 v[84:87], v11, s[36:39], s7 offen offset:2048 nt
    s_add_u32 s7, s7, 4096
    s_mov_b32 s58, 4000000
L_sp9:
    ds_read_b32 v47, v14 offset:40
    s_sub_u32 s58, s58, 1
    s_cbranch_scc1 L_end
    s_waitcnt lgkmcnt(0)
    v_readfirstlane_b32 s56, v47
    s_nop 0
    s_cmp_ge_u32 s56, 4
    s_cbranch_scc1 L_sd9
    s_sleep 1
    s_branch L_sp9
L_sd9:
    buffer_load_dwordx4 v[88:91], v11, s[36:39], s7 offen offset:0 nt
    buffer_load_dwordx4 v[92:95], v11, s[36:39], s7 offen offset:2048 nt
    buffer_load_dwordx4 v[96:99], v11, s[24:27], s5 offen offset:0 nt
    buffer_load_dwordx4 v[100:103], v11, s[24:27], s5 offen offset:2048 nt
    s_add_u32 s5, s5, 4096
    buffer_load_dwordx4 v[104:107], v11, s[24:27], s5 offen offset:0 nt
    s_mov_b32 s58, 4000000
L_sp10:
    ds_read_b32 v47, v14 offset:56
    s_sub_u32 s58, s58, 1
    s_cbranch_scc1 L_end
    s_waitcnt lgkmcnt(0)
    v_readfirstlane_b32 s56, v47
    s_nop 0
    s_cmp_ge_u32 s56, 4
    s_cbranch_scc0 L_sp10
    buffer_load_dwordx4 v[108:111], v11, s[24:27], s5 offen offset:2048 nt
    s_add_u32 s5, s5, 4096
    buffer_load_dwordx4 v[112:115], v11, s[24:27], s5 offen offset:0 nt
    buffer_load_dwordx4 v[116:119], v11, s[24:27], s5 offen offset:2048 nt
    s_add_u32 s5, s5, 4096
    buffer_load_dwordx4 v[120:123], v11, s[24:27], s5 offen offset:0 nt
    buffer_load_dwordx4 v[124:127], v11, s[24:27], s5 offen offset:2048 nt
    s_waitcnt vmcnt(8)
    s_mov_b64 exec, 1
    ds_add_u32 v14, v15 offset:32
    s_mov_b64 exec, -1
    s_cmp_eq_u32 s55, 0
    s_cbranch_scc1 L_wd_done
    s_mov_b32 s58, 4000000
L_sp11:
    ds_read_b32 v47, v14 offset:24
    s_sub_u32 s58, s58, 1
    s_cbranch_scc1 L_end
    s_waitcnt lgkmcnt(0)
    v_readfirstlane_b32 s56, v47
    s_nop 0
    s_cmp_eq_u32 s56, 1
    s_cbranch_scc1 L_sd11
    s_sleep 1
    s_branch L_sp11
L_sd11:
    ds_read_b128 v[16:19], v2 offset:64
    s_waitcnt vmcnt(8) lgkmcnt(0)
    v_perm_b32 v44, v68, v64, s60
    v_perm_b32 v45, v68, v64, s61
    v_dot2c_f32_bf16 v48, v44, v16
    v_dot2c_f32_bf16 v49, v45, v16
    v_perm_b32 v46, v69, v65, s60
    v_perm_b32 v47, v69, v65, s61
    v_dot2c_f32_bf16 v50, v46, v16
    v_dot2c_f32_bf16 v51, v47, v16
    v_perm_b32 v44, v70, v66, s60
    v_perm_b32 v45, v70, v66, s61
    v_dot2c_f32_bf16 v52, v44, v16
    v_dot2c_f32_bf16 v53, v45, v16
    v_perm_b32 v46, v71, v67, s60
    v_perm_b32 v47, v71, v67, s61
    v_dot2c_f32_bf16 v54, v46, v16
    v_dot2c_f32_bf16 v55, v47, v16
    v_perm_b32 v44, v76, v72, s60
    v_perm_b32 v45, v76, v72, s61
    v_dot2c_f32_bf16 v48, v44, v17
    v_dot2c_f32_bf16 v49, v45, v17
    v_perm_b32 v46, v77, v73, s60
    v_perm_b32 v47, v77, v73, s61
    v_dot2c_f32_bf16 v50, v46, v17
    v_dot2c_f32_bf16 v51, v47, v17
    v_perm_b32 v44, v78, v74, s60
    v_perm_b32 v45, v78, v74, s61
    v_dot2c_f32_bf16 v52, v44, v17
    v_dot2c_f32_bf16 v53, v45, v17
    v_perm_b32 v46, v79, v75, s60
    v_perm_b32 v47, v79, v75, s61
    v_dot2c_f32_bf16 v54, v46, v17
    v_dot2c_f32_bf16 v55, v47, v17
    v_perm_b32 v44, v84, v80, s60
    v_perm_b32 v45, v84, v80, s61
    v_dot2c_f32_bf16 v48, v44, v18
    v_dot2c_f32_bf16 v49, v45, v18
    v_perm_b32 v46, v85, v81, s60
    v_perm_b32 v47, v85, v81, s61
    v_dot2c_f32_bf16 v50, v46, v18
    v_dot2c_f32_bf16 v51, v47, v18
    v_perm_b32 v44, v86, v82, s60
    v_perm_b32 v45, v86, v82, s61
    v_dot2c_f32_bf16 v52, v44, v18
    v_dot2c_f32_bf16 v53, v45, v18
    v_perm_b32 v46, v87, v83, s60
    v_perm_b32 v47, v87, v83, s61
    v_dot2c_f32_bf16 v54, v46, v18
    v_dot2c_f32_bf16 v55, v47, v18
    v_perm_b32 v44, v92, v88, s60
    v_perm_b32 v45, v92, v88, s61
    v_dot2c_f32_bf16 v48, v44, v19
    v_dot2c_f32_bf16 v49, v45, v19
    v_perm_b32 v46, v93, v89, s60
    v_perm_b32 v47, v93, v89, s61
    v_dot2c_f32_bf16 v50, v46, v19
    v_dot2c_f32_bf16 v51, v47, v19
    v_perm_b32 v44, v94, v90, s60
    v_perm_b32 v45, v94, v90, s61
    v_dot2c_f32_bf16 v52, v44, v19
    v_dot2c_f32_bf16 v53, v45, v19
    v_perm_b32 v46, v95, v91, s60
    v_perm_b32 v47, v95, v91, s61
    v_dot2c_f32_bf16 v54, v46, v19
    v_dot2c_f32_bf16 v55, v47, v19
L_wd_done:
    s_waitcnt vmcnt(6)
    v_perm_b32 v46, v100, v96, s60
    v_perm_b32 v100, v100, v96, s61
    v_mov_b32 v96, v46
    v_perm_b32 v46, v101, v97, s60
    v_perm_b32 v101, v101, v97, s61
    v_mov_b32 v97, v46
    v_perm_b32 v46, v102, v98, s60
    v_perm_b32 v102, v102, v98, s61
    v_mov_b32 v98, v46
    v_perm_b32 v46, v103, v99, s60
    v_perm_b32 v103, v103, v99, s61
    v_mov_b32 v99, v46
    s_waitcnt vmcnt(4)
    v_perm_b32 v46, v108, v104, s60
    v_perm_b32 v108, v108, v104, s61
    v_mov_b32 v104, v46
    v_perm_b32 v46, v109, v105, s60
    v_perm_b32 v109, v109, v105, s61
    v_mov_b32 v105, v46
    v_perm_b32 v46, v110, v106, s60
    v_perm_b32 v110, v110, v106, s61
    v_mov_b32 v106, v46
    v_perm_b32 v46, v111, v107, s60
    v_perm_b32 v111, v111, v107, s61
    v_mov_b32 v107, v46
    s_waitcnt vmcnt(2)
    v_perm_b32 v46, v116, v112, s60
    v_perm_b32 v116, v116, v112, s61
    v_mov_b32 v112, v46
    v_perm_b32 v46, v117, v113, s60
    v_perm_b32 v117, v117, v113, s61
    v_mov_b32 v113, v46
    v_perm_b32 v46, v118, v114, s60
    v_perm_b32 v118, v118, v114, s61
    v_mov_b32 v114, v46
    v_perm_b32 v46, v119, v115, s60
    v_perm_b32 v119, v119, v115, s61
    v_mov_b32 v115, v46
    s_waitcnt vmcnt(0)
    v_perm_b32 v46, v124, v120, s60
    v_perm_b32 v124, v124, v120, s61
    v_mov_b32 v120, v46
    v_perm_b32 v46, v125, v121, s60
    v_perm_b32 v125, v125, v121, s61
    v_mov_b32 v121, v46
    v_perm_b32 v46, v126, v122, s60
    v_perm_b32 v126, v126, v122, s61
    v_mov_b32 v122, v46
    v_perm_b32 v46, v127, v123, s60
    v_perm_b32 v127, v127, v123, s61
    v_mov_b32 v123, v46
    s_mov_b32 s58, 4000000
L_sp12:
    ds_read_b32 v47, v14 offset:28
    ds_read_b128 v[16:19], v2 offset:128
    s_sub_u32 s58, s58, 1
    s_cbranch_scc1 L_end
    s_waitcnt lgkmcnt(0)
    v_readfirstlane_b32 s56, v47
    s_nop 0
    s_cmp_eq_u32 s56, 1
    s_cbranch_scc0 L_sp12
    v_dot2c_f32_bf16 v48, v96, v16
    v_dot2c_f32_bf16 v49, v100, v16
    v_dot2c_f32_bf16 v50, v97, v16
    v_dot2c_f32_bf16 v51, v101, v16
    v_dot2c_f32_bf16 v52, v98, v16
    v_dot2c_f32_bf16 v53, v102, v16
    v_dot2c_f32_bf16 v54, v99, v16
    v_dot2c_f32_bf16 v55, v103, v16
    v_dot2c_f32_bf16 v48, v104, v17
    v_dot2c_f32_bf16 v49, v108, v17
    v_dot2c_f32_bf16 v50, v105, v17
    v_dot2c_f32_bf16 v51, v109, v17
    v_dot2c_f32_bf16 v52, v106, v17
    v_dot2c_f32_bf16 v53, v110, v17
    v_dot2c_f32_bf16 v54, v107, v17
    v_dot2c_f32_bf16 v55, v111, v17
    v_dot2c_f32_bf16 v48, v112, v18
    v_dot2c_f32_bf16 v49, v116, v18
    v_dot2c_f32_bf16 v50, v113, v18
    v_dot2c_f32_bf16 v51, v117, v18
    v_dot2c_f32_bf16 v52, v114, v18
    v_dot2c_f32_bf16 v53, v118, v18
    v_dot2c_f32_bf16 v54, v115, v18
    v_dot2c_f32_bf16 v55, v119, v18
    v_dot2c_f32_bf16 v48, v120, v19
    v_dot2c_f32_bf16 v49, v124, v19
    v_dot2c_f32_bf16 v50, v121, v19
    v_dot2c_f32_bf16 v51, v125, v19
    v_dot2c_f32_bf16 v52, v122, v19
    v_dot2c_f32_bf16 v53, v126, v19
    v_dot2c_f32_bf16 v54, v123, v19
    v_dot2c_f32_bf16 v55, v127, v19
    s_nop 2
    v_permlane32_swap_b32 v48, v52
    v_permlane32_swap_b32 v49, v53
    v_permlane32_swap_b32 v50, v54
    v_permlane32_swap_b32 v51, v55
    v_add_f32 v48, v48, v52
    v_add_f32 v49, v49, v53
    v_add_f32 v50, v50, v54
    v_add_f32 v51, v51, v55
    v_mov_b32 v52, v48
    v_mov_b32 v53, v49
    v_mov_b32 v54, v50
    v_mov_b32 v55, v51
    v_permlane16_swap_b32 v48, v52
    v_permlane16_swap_b32 v49, v53
    v_permlane16_swap_b32 v50, v54
    v_permlane16_swap_b32 v51, v55
    v_add_f32 v48, v48, v52
    v_add_f32 v49, v49, v53
    v_add_f32 v50, v50, v54
    v_add_f32 v51, v51, v55
    v_add_u32 v48, v23, v48
    v_add_u32 v49, v23, v49
    v_add_u32 v50, v23, v50
    v_add_u32 v51, v23, v51
    v_perm_b32 v32, v48, v49, s90
    v_perm_b32 v33, v49, v22, s91
    v_perm_b32 v34, v50, v51, s90
    v_perm_b32 v35, v51, v22, s91
    s_mov_b32 exec_lo, 0xffff
    s_mov_b32 exec_hi, 0xffff
    buffer_store_dwordx4 v[32:35], v6, s[44:47], s92 offen sc1
    s_mov_b64 exec, -1
    s_waitcnt vmcnt(0)
L_final:
    s_cmp_ge_u32 s48, 64
    s_cbranch_scc1 L_fin
    s_and_b32 s5, s48, 31
    s_lshr_b32 s7, s48, 5
    s_lshl_b32 s7, s7, 5
    s_lshl_b32 s6, s5, 6
    s_add_u32 s6, s6, s7
    s_lshl_b32 s5, s5, 14
    s_add_u32 s5, s5, s7
    v_lshrrev_b32 v3, 2, v1
    v_lshlrev_b32 v3, 7, v3
    v_bfe_u32 v2, v1, 1, 1
    v_lshl_add_u32 v3, v2, 6, v3
    v_and_b32 v5, 1, v1
    v_lshl_add_u32 v3, v5, 4, v3
    v_lshl_add_u32 v2, v5, 1, v2
    v_lshl_add_u32 v2, v2, 2, v9
    v_lshlrev_b32 v4, 2, v1
    buffer_load_dword v16, v4, s[8:11], s6 offen
    s_lshl_b32 s7, s3, 11
    s_add_u32 s5, s5, s7
    s_add_u32 s92, s5, 2097152
    s_add_u32 s93, s92, 16384
    v_lshlrev_b32 v2, 5, v2
    s_lshl_b32 s5, s3, 2
    v_add_u32 v2, s5, v2
    v_lshlrev_b32 v5, 6, v1
    s_mov_b32 s20, 1
    s_mov_b32 s58, 1000000
    s_barrier
L_f_poll:
    buffer_load_dwordx4 v[32:35], v3, s[44:47], s92 offen offset:0 sc1
    s_sub_u32 s58, s58, 1
    s_cbranch_scc1 L_end
    s_waitcnt vmcnt(0)
    v_cmp_ne_u16 vcc, s89, v33
    v_cmp_ne_u16 s[56:57], s89, v35
    s_nop 0
    s_or_b64 vcc, vcc, s[56:57]
    s_cbranch_scc1 L_f_poll
    v_perm_b32 v33, v33, v32, s94
    v_and_b32 v32, s95, v32
    v_perm_b32 v35, v35, v34, s94
    v_and_b32 v34, s95, v34
    v_permlane16_swap_b32 v32, v33
    s_nop 0
    v_permlane16_swap_b32 v34, v35
    v_add_f32 v32, v32, v33
    v_add_f32 v34, v34, v35
    s_nop 1
    v_permlane32_swap_b32 v32, v34
    v_add_f32 v32, v32, v34
    s_nop 1
    v_add_f32_dpp v32, v32, v32 row_ror:8 row_mask:0xf bank_mask:0xf
    s_nop 1
    v_add_f32_dpp v32, v32, v32 row_ror:4 row_mask:0xf bank_mask:0xf
    s_mov_b32 exec_lo, 0xf000f
    s_mov_b32 exec_hi, 0xf000f
    ds_write_b32 v2, v32 offset:25600
    s_mov_b64 exec, 1
    ds_add_rtn_u32 v18, v14, v15 offset:48
    s_mov_b32 exec_lo, 0xff
    ds_read_b128 v[32:35], v5 offset:25600
    ds_read_b128 v[36:39], v5 offset:25616
    ds_read_b128 v[40:43], v5 offset:25632
    ds_read_b128 v[44:47], v5 offset:25648
    v_and_b32 v17, s62, v16
    v_lshlrev_b32 v16, 16, v16
    s_waitcnt lgkmcnt(0)
    v_readfirstlane_b32 s56, v18
    s_nop 0
    s_cmp_lg_u32 s56, 7
    s_cbranch_scc1 L_fin
    v_add_f32 v32, v32, v33
    v_add_f32 v34, v34, v35
    v_add_f32 v36, v36, v37
    v_add_f32 v38, v38, v39
    v_add_f32 v32, v32, v34
    v_add_f32 v36, v36, v38
    v_add_f32 v32, v32, v36
    v_add_f32 v40, v40, v41
    v_add_f32 v42, v42, v43
    v_add_f32 v44, v44, v45
    v_add_f32 v46, v46, v47
    v_add_f32 v40, v40, v42
    v_add_f32 v44, v44, v46
    v_add_f32 v40, v40, v44
    v_add_f32 v32, v32, v16
    v_add_f32 v40, v40, v17
    v_cvt_pk_bf16_f32 v32, v32, v40
    buffer_store_dword v32, v4, s[40:43], s6 offen
L_fin:
L_end:
    s_endpgm
L_code_end:
.section .rodata,"a"
.p2align 6
.amdhsa_kernel parallel_sum__gqa_block_cached__swiglu_ffn__decode_kernel
  .amdhsa_next_free_vgpr 256
  .amdhsa_next_free_sgpr 102
  .amdhsa_accum_offset 256
  .amdhsa_group_segment_fixed_size 0
  .amdhsa_kernarg_size 96
  .amdhsa_user_sgpr_count 2
  .amdhsa_user_sgpr_kernarg_segment_ptr 1
  .amdhsa_system_sgpr_workgroup_id_x 1
  .amdhsa_float_denorm_mode_32 3
.end_amdhsa_kernel
```
